```python
import torch

def _softmax(x, axis=-1):
    return torch.softmax(x, dim=axis)
def _gelu(x):
    return torch.nn.functional.gelu(x, approximate="tanh")
def _silu(x):
    return torch.nn.functional.silu(x)
def _sigmoid(x):
    return torch.sigmoid(x)
def _layernorm(x, axis=-1, eps=1e-5):
    m = x.mean(dim=axis, keepdim=True)
    v = x.var(dim=axis, keepdim=True, unbiased=False)
    return (x - m) / torch.sqrt(v + eps)
def _scatter_add(tgt, idx, src, axis=0):
    return tgt.clone().index_add_(axis, idx, src)
def _segment_sum(src, seg, n):
    out = torch.zeros((n,) + src.shape[1:], dtype=src.dtype)
    return out.index_add_(0, seg, src)
def _pad(x, pw):
    flat = tuple(v for pair in reversed(pw) for v in pair)
    return torch.nn.functional.pad(x, flat)

kernel_name = 'sequential_preLN__ssm_conv_h3__geglu_ffn__prompt'

def setup_inputs():

    _w = (lambda a: (lambda t: t.to(torch.bfloat16) if t.is_floating_point() else t)(torch.as_tensor(a)))
    def _A_setup():
        B, S, D = 1, 2048, 512
        ks = 4
        return {
            "q": _w((lambda *s: torch.randn(*s, dtype=torch.bfloat16) * 0.05)(B, S, D)),
            "k": _w((lambda *s: torch.randn(*s, dtype=torch.bfloat16) * 0.4)(B, S, D)),
            "v": _w((lambda *s: torch.randn(*s, dtype=torch.bfloat16) * 0.4)(B, S, D)),
            "shift_k": _w((lambda *s: torch.randn(*s, dtype=torch.bfloat16) * 0.4)(D, ks) * 0.5),
            "ssm_k": _w((lambda *s: torch.randn(*s, dtype=torch.bfloat16) * 0.4)(D, S) * (1.0 / S ** 0.5)),
            "ssm_D": _w((lambda *s: torch.randn(*s, dtype=torch.bfloat16) * 0.4)(D)),
        }
    _A_in = _A_setup()

    def _B_setup():
        B, S, D, F = 1, 2048, 512, 1792
        return {
            "x": _w((lambda *s: torch.randn(*s, dtype=torch.bfloat16) * 0.05)(B, S, D)),
            "w_gate": _w((lambda *s: torch.randn(*s, dtype=torch.bfloat16) * 0.05)(D, F)),
            "w_up": _w((lambda *s: torch.randn(*s, dtype=torch.bfloat16) * 0.05)(D, F)),
            "w_down": _w((lambda *s: torch.randn(*s, dtype=torch.bfloat16) * 0.05)(F, D)),
        }
    _B_in = _B_setup()

    return {
        "A_q": _A_in["q"],
        "A_k": _A_in["k"],
        "A_v": _A_in["v"],
        "A_shift_k": _A_in["shift_k"],
        "A_ssm_k": _A_in["ssm_k"],
        "A_ssm_D": _A_in["ssm_D"],
        "B_x": _B_in["x"],
        "B_w_gate": _B_in["w_gate"],
        "B_w_up": _B_in["w_up"],
        "B_w_down": _B_in["w_down"],
    }

def reference(A_q, A_k, A_v, A_shift_k, A_ssm_k, A_ssm_D, B_x, B_w_gate, B_w_up, B_w_down):
    def _A_ref(q, k, v, shift_k, ssm_k, ssm_D):
        B, S, D = q.shape
        ks = shift_k.shape[-1]
        k_pad = _pad(k, ((0, 0), (ks - 1, 0), (0, 0)))
        k_shift = torch.zeros_like(k)
        for t in range(ks):
            k_shift = k_shift + k_pad[:, t:t + S, :] * shift_k[:, ks - 1 - t][None, None, :]
        kv = k_shift * v
        L = 2 * S
        kv_pad = _pad(kv, ((0, 0), (0, S), (0, 0)))
        kf_pad = _pad(ssm_k, ((0, 0), (0, S)))
        kv_f = (lambda x, axes=(-2,-1): torch.fft.rfft2(x.float(), dim=axes))(kv_pad[:, None, :, :], axes=(1, 2))
        kf_f = (lambda x, axes=(-2,-1): torch.fft.rfft2(x.float(), dim=axes))(kf_pad[:, None, :], axes=(1, 2))
        kf_f = (lambda x, *d: x.permute(*d))(kf_f, 1, 2, 0)
        y_f = kv_f * kf_f[None, :, :, :]
        y = (lambda x, s, axes=(-2,-1): torch.fft.irfft2(x, s=s, dim=axes).to(torch.bfloat16))(y_f, (1, L), axes=(1, 2))[:, 0, :S, :]
        y = y + kv * ssm_D[None, None, :]
        return q * y

    def _B_ref(x, w_gate, w_up, w_down):
        return (_gelu(x @ w_gate) * (x @ w_up)) @ w_down

    x = A_q
    h = x + _A_ref(_layernorm(x, axis=-1), A_k, A_v, A_shift_k, A_ssm_k, A_ssm_D)
    h2 = h + _B_ref(_layernorm(h, axis=-1), B_w_gate, B_w_up, B_w_down)
    return h2
```

```asm
; @launch grid=(256,1,1) block=(256,1,1) lds=163840
.amdgcn_target "amdgcn-amd-amdhsa--gfx950"
.text
.globl sequential_preLN__ssm_conv_h3__geglu_ffn__prompt_kernel
.p2align 8
.type sequential_preLN__ssm_conv_h3__geglu_ffn__prompt_kernel,@function
sequential_preLN__ssm_conv_h3__geglu_ffn__prompt_kernel:
    s_cmp_ge_u32 s2, 256
    s_cbranch_scc1 L_end
    s_load_dwordx2 s[36:37], s[0:1], 8
    s_load_dwordx2 s[40:41], s[0:1], 16
    s_load_dwordx2 s[32:33], s[0:1], 0
    s_load_dwordx2 s[64:65], s[0:1], 96
    s_load_dwordx2 s[10:11], s[0:1], 24
    v_lshrrev_b32 v1, 6, v0
    s_getpc_b64 s[72:73]
L_pcbase:
    v_readfirstlane_b32 s30, v1
    s_and_b32 s3, s2, 0xf8
    v_lshrrev_b32 v2, 5, v0
    v_add_u32 v2, s3, v2
    v_lshlrev_b32 v2, 7, v2
    v_min_u32 v2, L_end-L_pcbase, v2
    global_load_dword a251, v2, s[72:73]
    v_and_b32 v0, 63, v0
    v_lshrrev_b32 v1, 3, v0
    v_and_b32 v2, 7, v0
    v_and_b32 v3, 2, v1
    v_xor_b32 v2, v2, v3
    v_lshlrev_b32 v2, 4, v2
    v_lshl_add_u32 v14, v1, 10, v2
    s_and_b32 s77, s2, 31
    s_lshr_b32 s78, s2, 5
    s_lshl_b32 s3, s77, 2
    s_add_u32 s3, s3, s30
    s_lshl_b32 s3, s3, 7
    s_add_u32 s3, s3, s78
    s_lshl_b32 s3, s3, 7
    v_add_u32 v14, s3, v14
    v_xor_b32 v16, 64, v14
    v_add_u32 v15, 7168, v16
    s_mov_b32 s38, 2097152
    s_mov_b32 s39, 0x20000
    s_mov_b64 s[42:43], s[38:39]
    s_mov_b64 s[34:35], s[38:39]
    s_lshl_b32 s74, s30, 11
    s_add_u32 m0, s74, 1024
    s_lshl_b32 s3, s2, 2
    s_add_u32 s79, s3, s30
    s_and_b32 s75, s79, 0x3e3
    s_cmp_eq_u32 s75, 1
    s_waitcnt lgkmcnt(0)
    s_cbranch_scc1 L_init
L_initdone:
    buffer_load_dwordx4 v14, s[36:39], 0 offen lds
    buffer_load_dwordx4 v15, s[36:39], 0 offen offset:1024 lds
    s_add_u32 m0, s74, 9216
    s_nop 0
    buffer_load_dwordx4 v14, s[40:43], 0 offen lds
    buffer_load_dwordx4 v15, s[40:43], 0 offen offset:1024 lds
    s_add_u32 m0, s74, 17408
    s_nop 0
    buffer_load_dwordx4 v14, s[32:35], 0 offen lds
    buffer_load_dwordx4 v15, s[32:35], 0 offen offset:1024 lds
    s_cmp_lg_u32 s30, 0
    s_cbranch_scc1 L_nohalo
    s_mov_b32 m0, 0
    v_subrev_u32 v16, 8192, v16
    buffer_load_dwordx4 v16, s[36:39], 0 offen lds
    s_branch L_nohalo
L_init:
    s_mov_b32 s66, 33554432
    s_mov_b32 s67, 0x20000
    v_lshlrev_b32 v1, 11, v0
    v_mov_b32 v2, 0
    s_lshl_b32 s3, s2, 8
    s_add_u32 s3, s3, 6422528
    buffer_store_dword v2, v1, s[64:67], s3 offen sc1
    s_branch L_initdone
L_nohalo:
    v_lshrrev_b32 v1, 5, v0
    v_and_b32 v2, 31, v0
    v_lshlrev_b32 v2, 4, v2
    v_lshl_add_u32 v17, v1, 10, v2
    s_lshl_b32 s3, s2, 2
    s_lshl_b32 s75, s77, 3
    s_add_u32 s75, s75, s78
    s_lshl_b32 s75, s75, 2
    s_add_u32 s29, s75, s30
    s_lshl_b32 s75, s29, 11
    v_and_b32 v18, 15, v0
    s_lshl_b32 s76, s78, 6
    s_lshl_b32 s74, s30, 4
    s_add_u32 s76, s76, s74
    v_add_u32 v18, s76, v18
    v_lshlrev_b32 v19, 3, v18
    global_load_dwordx2 v[12:13], v19, s[10:11]
    buffer_load_dwordx4 v[4:7], v17, s[32:35], s75 offen
    buffer_load_dwordx4 v[8:11], v17, s[32:35], s75 offen offset:512
    s_load_dwordx4 s[12:15], s[0:1], 32
    s_load_dwordx2 s[18:19], s[0:1], 56
    s_load_dwordx8 s[20:27], s[0:1], 64
    s_mov_b32 s66, 33554432
    s_mov_b32 s67, 0x20000
    s_waitcnt lgkmcnt(0)
    s_load_dword s31, s[14:15], s3
    v_mov_b32 v2, 0
    s_cmp_lg_u32 s30, 2
    s_cbranch_scc1 L_noinit2
    v_lshlrev_b32 v1, 8, v0
    s_mul_i32 s3, s2, 2560
    s_add_u32 s3, s3, 6553600
    s_mov_b64 exec, 0x3ff
    buffer_store_dword v2, v1, s[64:67], s3 offen sc1
    s_mov_b64 exec, -1
L_noinit2:
    s_lshr_b32 s3, s79, 1
    s_lshl_b32 s3, s3, 12
    s_add_u32 s44, s12, s3
    s_addc_u32 s45, s13, 0
    s_mov_b32 s46, 4096
    s_mov_b32 s47, 0x20000
    s_lshr_b32 s3, s79, 1
    s_mul_i32 s3, s3, 4096
    s_add_u32 s3, s3, 17825792
    s_add_u32 s68, s64, s3
    s_addc_u32 s69, s65, 0
    s_mov_b32 s70, 4096
    s_mov_b32 s71, 0x20000
    s_lshr_b32 s3, s30, 1
    s_mul_i32 s95, s3, 25920
    s_add_u32 s95, s95, 99840
    s_and_b32 s94, s30, 1
    s_lshl_b32 s3, s94, 2
    v_lshrrev_b32 v1, 5, v0
    v_and_b32 v2, 31, v0
    v_add_u32 v3, v1, v2
    v_lshlrev_b32 v3, 1, v3
    v_add_u32 v3, s3, v3
    v_subrev_u32 v23, 54, v3
    s_mul_i32 s74, s94, 8320
    s_add_u32 s74, s74, s95
    v_mul_u32_u24 v21, 4160, v1
    v_lshl_add_u32 v21, v2, 1, v21
    v_add_u32 v21, s74, v21
    v_lshlrev_b32 v22, 4, v0
    buffer_load_ushort v20, v23, s[44:47], 0 offen
    s_and_b32 s74, s79, 0x3e3
    s_cmp_lg_u32 s74, 1
    s_cbranch_scc1 L_noflag
    s_waitcnt vmcnt(10)
    s_mov_b64 exec, 1
    s_lshl_b32 s74, s2, 2
    v_mov_b32 v1, s74
    v_mov_b32 v2, 1
    global_store_dword v1, v2, s[26:27] sc1
    s_mov_b64 exec, -1
L_noflag:
    s_mul_i32 s3, s94, 4640
    s_add_u32 s3, s3, s95
    s_add_u32 s93, s3, 16640
    v_and_b32 v1, 31, v0
    v_lshlrev_b32 v1, 4, v1
    v_add_u32 v1, s93, v1
    v_mov_b32 v24, 0
    v_mov_b32 v25, 0
    v_mov_b32 v26, 0
    v_mov_b32 v27, 0
    ds_write_b128 v1, v[24:27] offset:4096
    s_mov_b32 s48, s18
    s_mov_b32 s49, s19
    s_mov_b32 s50, 1835008
    s_mov_b32 s51, 0x20000
    s_sub_u32 s52, s20, 1024
    s_subb_u32 s53, s21, 0
    s_mov_b32 s54, 1836032
    s_mov_b32 s55, 0x20000
    s_mov_b32 s56, s22
    s_mov_b32 s57, s23
    s_mov_b32 s58, 1835008
    s_mov_b32 s59, 0x20000
    s_mov_b32 s60, s24
    s_mov_b32 s61, s25
    s_mov_b32 s62, 2097152
    s_mov_b32 s63, 0x20000
    v_bfe_u32 v1, v0, 2, 2
    v_lshrrev_b32 v2, 4, v0
    v_lshl_add_u32 v3, v2, 3, v1
    v_lshlrev_b32 v14, 7, v3
    v_lshrrev_b32 v1, 1, v1
    v_and_b32 v3, 1, v2
    v_lshl_add_u32 v1, v3, 1, v1
    v_xor_b32 v1, s30, v1
    v_lshl_add_u32 v14, v1, 5, v14
    v_and_b32 v1, 3, v0
    v_lshl_add_u32 v14, v1, 3, v14
    v_xor_b32 v15, 64, v14
    s_lshl_b32 s3, s77, 7
    v_lshlrev_b32 v2, 4, v2
    v_add_u32 v2, s3, v2
    v_mul_u32_u24 v18, 4096, v18
    v_add_u32 v16, v18, v2
    v_sub_u32 v18, v18, v2
    v_add_u32 v18, 17829808, v18
    s_waitcnt vmcnt(3) lgkmcnt(0)
    s_barrier
    ds_read_b64_tr_b16 v[28:29], v15 offset:512
    ds_read_b64_tr_b16 v[30:31], v14 offset:1024
    ds_read_b64_tr_b16 v[32:33], v14 offset:1536
    ds_read_b64_tr_b16 v[40:41], v14 offset:9216
    ds_read_b64_tr_b16 v[42:43], v14 offset:9728
    ds_read_b64_tr_b16 v[34:35], v15 offset:4608
    ds_read_b64_tr_b16 v[36:37], v14 offset:5120
    ds_read_b64_tr_b16 v[38:39], v14 offset:5632
    ds_read_b64_tr_b16 v[44:45], v14 offset:13312
    ds_read_b64_tr_b16 v[46:47], v14 offset:13824
    ds_read_b64_tr_b16 v[48:49], v14 offset:17408
    ds_read_b64_tr_b16 v[50:51], v14 offset:17920
    ds_read_b64_tr_b16 v[52:53], v14 offset:21504
    ds_read_b64_tr_b16 v[54:55], v14 offset:22016
    v_lshlrev_b32 v56, 16, v12
    v_and_b32 v57, 0xffff0000, v12
    v_lshlrev_b32 v58, 16, v13
    v_and_b32 v59, 0xffff0000, v13
    s_mov_b32 s3, 0
    s_waitcnt lgkmcnt(9)
    v_and_b32 v65, 0xffff0000, v28
    v_lshlrev_b32 v66, 16, v29
    v_and_b32 v67, 0xffff0000, v29
    v_lshlrev_b32 v68, 16, v30
    v_and_b32 v69, 0xffff0000, v30
    v_lshlrev_b32 v70, 16, v31
    v_and_b32 v71, 0xffff0000, v31
    v_lshlrev_b32 v72, 16, v32
    v_and_b32 v73, 0xffff0000, v32
    v_lshlrev_b32 v74, 16, v33
    v_and_b32 v75, 0xffff0000, v33
    v_lshlrev_b32 v76, 16, v40
    v_and_b32 v77, 0xffff0000, v40
    v_lshlrev_b32 v78, 16, v41
    v_and_b32 v79, 0xffff0000, v41
    v_lshlrev_b32 v80, 16, v42
    v_and_b32 v81, 0xffff0000, v42
    v_lshlrev_b32 v82, 16, v43
    v_and_b32 v83, 0xffff0000, v43
    v_mul_f32 v84, v59, v65
    v_mul_f32 v85, v59, v66
    v_mul_f32 v86, v59, v67
    v_mul_f32 v87, v59, v68
    v_mul_f32 v88, v59, v69
    v_mul_f32 v89, v59, v70
    v_mul_f32 v90, v59, v71
    v_mul_f32 v91, v59, v72
    v_fmac_f32 v84, v58, v66
    v_fmac_f32 v85, v58, v67
    v_fmac_f32 v86, v58, v68
    v_fmac_f32 v87, v58, v69
    v_fmac_f32 v88, v58, v70
    v_fmac_f32 v89, v58, v71
    v_fmac_f32 v90, v58, v72
    v_fmac_f32 v91, v58, v73
    v_fmac_f32 v84, v57, v67
    v_fmac_f32 v85, v57, v68
    v_fmac_f32 v86, v57, v69
    v_fmac_f32 v87, v57, v70
    v_fmac_f32 v88, v57, v71
    v_fmac_f32 v89, v57, v72
    v_fmac_f32 v90, v57, v73
    v_fmac_f32 v91, v57, v74
    v_fmac_f32 v84, v56, v68
    v_fmac_f32 v85, v56, v69
    v_fmac_f32 v86, v56, v70
    v_fmac_f32 v87, v56, v71
    v_fmac_f32 v88, v56, v72
    v_fmac_f32 v89, v56, v73
    v_fmac_f32 v90, v56, v74
    v_fmac_f32 v91, v56, v75
    v_pk_mul_f32 v[84:85], v[84:85], v[76:77]
    v_pk_mul_f32 v[86:87], v[86:87], v[78:79]
    v_pk_mul_f32 v[88:89], v[88:89], v[80:81]
    v_pk_mul_f32 v[90:91], v[90:91], v[82:83]
    v_cvt_pk_bf16_f32 v92, v91, v90
    v_cvt_pk_bf16_f32 v93, v89, v88
    v_cvt_pk_bf16_f32 v94, v87, v86
    v_cvt_pk_bf16_f32 v95, v85, v84
    buffer_store_dwordx4 v[92:95], v18, s[64:67], 0 offen offset:64 sc1
    s_waitcnt lgkmcnt(4)
    v_and_b32 v65, 0xffff0000, v34
    v_lshlrev_b32 v66, 16, v35
    v_and_b32 v67, 0xffff0000, v35
    v_lshlrev_b32 v68, 16, v36
    v_and_b32 v69, 0xffff0000, v36
    v_lshlrev_b32 v70, 16, v37
    v_and_b32 v71, 0xffff0000, v37
    v_lshlrev_b32 v72, 16, v38
    v_and_b32 v73, 0xffff0000, v38
    v_lshlrev_b32 v74, 16, v39
    v_and_b32 v75, 0xffff0000, v39
    v_lshlrev_b32 v76, 16, v44
    v_and_b32 v77, 0xffff0000, v44
    v_lshlrev_b32 v78, 16, v45
    v_and_b32 v79, 0xffff0000, v45
    v_lshlrev_b32 v80, 16, v46
    v_and_b32 v81, 0xffff0000, v46
    v_lshlrev_b32 v82, 16, v47
    v_and_b32 v83, 0xffff0000, v47
    v_mul_f32 v84, v59, v65
    v_mul_f32 v85, v59, v66
    v_mul_f32 v86, v59, v67
    v_mul_f32 v87, v59, v68
    v_mul_f32 v88, v59, v69
    v_mul_f32 v89, v59, v70
    v_mul_f32 v90, v59, v71
    v_mul_f32 v91, v59, v72
    v_fmac_f32 v84, v58, v66
    v_fmac_f32 v85, v58, v67
    v_fmac_f32 v86, v58, v68
    v_fmac_f32 v87, v58, v69
    v_fmac_f32 v88, v58, v70
    v_fmac_f32 v89, v58, v71
    v_fmac_f32 v90, v58, v72
    v_fmac_f32 v91, v58, v73
    v_fmac_f32 v84, v57, v67
    v_fmac_f32 v85, v57, v68
    v_fmac_f32 v86, v57, v69
    v_fmac_f32 v87, v57, v70
    v_fmac_f32 v88, v57, v71
    v_fmac_f32 v89, v57, v72
    v_fmac_f32 v90, v57, v73
    v_fmac_f32 v91, v57, v74
    v_fmac_f32 v84, v56, v68
    v_fmac_f32 v85, v56, v69
    v_fmac_f32 v86, v56, v70
    v_fmac_f32 v87, v56, v71
    v_fmac_f32 v88, v56, v72
    v_fmac_f32 v89, v56, v73
    v_fmac_f32 v90, v56, v74
    v_fmac_f32 v91, v56, v75
    v_pk_mul_f32 v[84:85], v[84:85], v[76:77]
    v_pk_mul_f32 v[86:87], v[86:87], v[78:79]
    v_pk_mul_f32 v[88:89], v[88:89], v[80:81]
    v_pk_mul_f32 v[90:91], v[90:91], v[82:83]
    v_cvt_pk_bf16_f32 v96, v91, v90
    v_cvt_pk_bf16_f32 v97, v89, v88
    v_cvt_pk_bf16_f32 v98, v87, v86
    v_cvt_pk_bf16_f32 v99, v85, v84
    buffer_store_dwordx4 v[96:99], v18, s[64:67], 0 offen sc1
    s_waitcnt lgkmcnt(0)
    buffer_store_dwordx4 v[48:51], v16, s[64:67], s3 offen sc1
    buffer_store_dwordx4 v[52:55], v16, s[64:67], s3 offen offset:64 sc1
    s_waitcnt vmcnt(5)
    v_lshlrev_b32 v64, 16, v4
    v_and_b32 v65, 0xffff0000, v4
    v_lshlrev_b32 v66, 16, v5
    v_and_b32 v67, 0xffff0000, v5
    v_lshlrev_b32 v68, 16, v6
    v_and_b32 v69, 0xffff0000, v6
    v_lshlrev_b32 v70, 16, v7
    v_and_b32 v71, 0xffff0000, v7
    v_lshlrev_b32 v72, 16, v8
    v_and_b32 v73, 0xffff0000, v8
    v_lshlrev_b32 v74, 16, v9
    v_and_b32 v75, 0xffff0000, v9
    v_lshlrev_b32 v76, 16, v10
    v_and_b32 v77, 0xffff0000, v10
    v_lshlrev_b32 v78, 16, v11
    v_and_b32 v79, 0xffff0000, v11
    v_pk_add_f32 v[4:5], v[64:65], v[66:67]
    v_pk_mul_f32 v[6:7], v[64:65], v[64:65]
    v_pk_fma_f32 v[6:7], v[66:67], v[66:67], v[6:7]
    v_pk_add_f32 v[4:5], v[4:5], v[68:69]
    v_pk_fma_f32 v[6:7], v[68:69], v[68:69], v[6:7]
    v_pk_add_f32 v[4:5], v[4:5], v[70:71]
    v_pk_fma_f32 v[6:7], v[70:71], v[70:71], v[6:7]
    v_pk_add_f32 v[4:5], v[4:5], v[72:73]
    v_pk_fma_f32 v[6:7], v[72:73], v[72:73], v[6:7]
    v_pk_add_f32 v[4:5], v[4:5], v[74:75]
    v_pk_fma_f32 v[6:7], v[74:75], v[74:75], v[6:7]
    v_pk_add_f32 v[4:5], v[4:5], v[76:77]
    v_pk_fma_f32 v[6:7], v[76:77], v[76:77], v[6:7]
    v_pk_add_f32 v[4:5], v[4:5], v[78:79]
    v_pk_fma_f32 v[6:7], v[78:79], v[78:79], v[6:7]
    v_add_f32 v4, v4, v5
    v_add_f32 v5, v6, v7
    s_nop 0
    v_add_f32_dpp v4, v4, v4 row_ror:8 row_mask:0xf bank_mask:0xf
    v_add_f32_dpp v5, v5, v5 row_ror:8 row_mask:0xf bank_mask:0xf
    s_nop 0
    v_add_f32_dpp v4, v4, v4 row_ror:4 row_mask:0xf bank_mask:0xf
    v_add_f32_dpp v5, v5, v5 row_ror:4 row_mask:0xf bank_mask:0xf
    s_nop 0
    v_add_f32_dpp v4, v4, v4 row_ror:2 row_mask:0xf bank_mask:0xf
    v_add_f32_dpp v5, v5, v5 row_ror:2 row_mask:0xf bank_mask:0xf
    s_nop 0
    v_add_f32_dpp v4, v4, v4 row_ror:1 row_mask:0xf bank_mask:0xf
    v_add_f32_dpp v5, v5, v5 row_ror:1 row_mask:0xf bank_mask:0xf
    s_nop 0
    v_mov_b32 v6, v4
    v_mov_b32 v7, v5
    s_nop 1
    v_permlane16_swap_b32 v4, v6
    v_permlane16_swap_b32 v5, v7
    s_nop 0
    v_add_f32 v4, v4, v6
    v_add_f32 v5, v5, v7
    s_mov_b32 s76, 989855744
    v_mul_f32 v4, s76, v4
    v_mul_f32 v5, s76, v5
    v_fma_f32 v5, -v4, v4, v5
    v_max_f32 v5, 0, v5
    v_cvt_pk_bf16_f32 v5, v5, v5
    v_and_b32 v5, 0xffff0000, v5
    v_add_f32 v5, 925353388, v5
    v_cvt_pk_bf16_f32 v5, v5, v5
    v_and_b32 v5, 0xffff0000, v5
    v_sqrt_f32 v5, v5
    v_cvt_pk_bf16_f32 v4, v4, v4
    v_and_b32 v4, 0xffff0000, v4
    v_cvt_pk_bf16_f32 v5, v5, v5
    v_and_b32 v5, 0xffff0000, v5
    v_rcp_f32 v5, v5
    v_and_b32 v2, 1, v0
    v_cmp_eq_u32 vcc, 1, v2
    v_lshrrev_b32 v1, 5, v0
    v_lshlrev_b32 v1, 2, v1
    v_lshl_add_u32 v1, v2, 13, v1
    v_cndmask_b32 v4, v4, v5, vcc
    s_lshl_b32 s3, s29, 3
    s_add_u32 s3, s3, 6291456
    s_mov_b32 exec_lo, 3
    s_mov_b32 exec_hi, 3
    buffer_store_dword v4, v1, s[64:67], s3 offen sc1
    s_mov_b64 exec, -1
    v_and_b32 v19, 7, v0
    v_lshlrev_b32 v19, 2, v19
    global_load_dword v12, v19, s[26:27] sc1
    s_lshl_b32 s3, s94, 2
    s_add_u32 s3, s3, 8
    buffer_load_dwordx4 v[104:107], v22, s[44:47], s3 offen offset:4
    buffer_load_dword v100, v22, s[44:47], s3 offen offset:0
    buffer_load_dwordx4 v[108:111], v22, s[44:47], s3 offen offset:1028
    buffer_load_dword v101, v22, s[44:47], s3 offen offset:1024
    buffer_load_dwordx4 v[112:115], v22, s[44:47], s3 offen offset:2052
    buffer_load_dword v102, v22, s[44:47], s3 offen offset:2048
    buffer_load_dwordx4 v[116:119], v22, s[44:47], s3 offen offset:3076
    buffer_load_dword v103, v22, s[44:47], s3 offen offset:3072
    s_min_u32 s3, s2, 223
    s_cmp_ge_u32 s3, 112
    s_cselect_b32 s74, 112, 0
    s_cselect_b32 s92, 1792, 0
    s_cselect_b32 s4, s20, s18
    s_cselect_b32 s5, s21, s19
    s_mov_b32 s6, 1835008
    s_mov_b32 s7, 0x20000
    s_sub_u32 s3, s3, s74
    s_mul_i32 s74, s3, 2341
    s_lshr_b32 s74, s74, 16
    s_mul_i32 s75, s74, 28
    s_sub_u32 s75, s3, s75
    s_mul_i32 s76, s74, 3584
    s_add_u32 s92, s92, s76
    s_lshl_b32 s76, s75, 6
    s_add_u32 s92, s92, s76
    s_lshl_b32 s76, s30, 4
    s_add_u32 s92, s92, s76
    s_lshl_b32 s92, s92, 2
    s_add_u32 s92, s92, 6356992
    s_lshl_b32 s74, s74, 2
    s_add_u32 s74, s74, s30
    s_mul_i32 s74, s74, 114688
    s_lshl_b32 s75, s75, 7
    s_add_u32 s3, s74, s75
    v_lshrrev_b32 v1, 3, v0
    v_and_b32 v2, 7, v0
    v_and_b32 v3, 6, v1
    v_xor_b32 v2, v2, v3
    v_lshlrev_b32 v2, 4, v2
    v_lshl_add_u32 v62, v1, 10, v2
    v_mul_u32_u24 v1, 3584, v1
    v_add_u32 v1, v1, v2
    v_mov_b32 v14, v1
    s_mov_b32 s28, s3
    v_lshrrev_b32 v1, 2, v0
    v_lshlrev_b32 v60, 7, v1
    v_bfe_u32 v1, v1, 1, 2
    v_lshl_add_u32 v60, v1, 5, v60
    v_and_b32 v1, 3, v0
    v_lshl_add_u32 v60, v1, 3, v60
    s_lshl_b32 s3, s30, 5
    v_xor_b32 v61, s3, v60
    v_mov_b32 v1, 0x3f803f80
    v_accvgpr_write_b32 a252, v1
    v_accvgpr_write_b32 a253, v1
    v_accvgpr_write_b32 a254, v1
    v_accvgpr_write_b32 a255, v1
    v_lshrrev_b32 v1, 4, v0
    v_and_b32 v2, 1, v0
    v_bfe_u32 v3, v0, 1, 3
    v_lshlrev_b32 v4, 3, v1
    v_lshl_add_u32 v4, v2, 2, v4
    v_lshl_add_u32 v4, v3, 5, v4
    s_lshl_b32 s3, s94, 10
    v_add_u32 v4, s3, v4
    v_lshlrev_b32 v5, 1, v4
    v_lshlrev_b32 v6, 2, v4
    v_add_u32 v7, 8192, v6
    s_lshr_b32 s3, s79, 1
    s_mul_i32 s77, s3, 4096
    s_add_u32 s77, s77, 0
    s_lshl_b32 s78, s3, 8
    s_add_u32 s78, s78, 4194304
    v_lshrrev_b32 v13, 8, v5
    v_lshlrev_b32 v13, 17, v13
    v_and_b32 v11, 255, v5
    v_add_u32 v13, v13, v11
    v_and_b32 v8, 3, v0
    v_mul_u32_u24 v8, 4160, v8
    v_bfe_u32 v11, v0, 2, 2
    v_add_u32 v11, v11, v1
    v_lshl_add_u32 v8, v11, 4, v8
    s_lshl_b32 s3, s94, 8
    s_add_u32 s3, s3, s95
    v_add_u32 v8, s3, v8
    v_mul_u32_u24 v9, 4640, v2
    v_lshl_add_u32 v9, v1, 4, v9
    v_lshlrev_b32 v11, 6, v3
    v_sub_u32 v9, v9, v11
    s_add_u32 s3, s3, 17088
    v_add_u32 v9, s3, v9
    s_add_u32 s3, s95, 23832
    v_sub_u32 v10, s3, v5
    s_and_b32 s3, s2, 7
    s_lshr_b32 s74, s2, 3
    s_lshr_b32 s75, s3, 1
    s_and_b32 s76, s3, 1
    s_mul_i32 s90, s75, 4
    s_and_b32 s75, s74, 3
    s_add_u32 s90, s90, s75
    s_mul_i32 s91, s76, 8
    s_lshr_b32 s75, s74, 2
    s_add_u32 s91, s91, s75
    v_lshrrev_b32 v1, 4, v0
    s_lshl_b32 s3, s30, 3
    v_add_u32 v1, s3, v1
    v_and_b32 v2, 15, v0
    v_lshlrev_b32 v58, 8, v1
    v_lshl_add_u32 v58, v2, 4, v58
    s_lshl_b32 s3, s90, 17
    v_add_u32 v58, s3, v58
    v_add_u32 v59, -32, v58
    v_min_u32 v2, 13, v2
    v_mul_u32_u24 v56, 3584, v1
    v_lshl_add_u32 v56, v2, 4, v56
    s_mul_i32 s3, s91, 224
    v_add_u32 v56, s3, v56
    v_add_u32 v57, 12256, v56
    s_mul_i32 s88, s30, 4160
    s_mul_i32 s89, s30, 2112
    s_add_u32 s89, s89, 99840
    s_and_b32 s3, s91, 7
    s_mul_i32 s80, s3, 2
    s_and_b32 s3, s90, 3
    s_mul_i32 s3, s3, 0
    s_add_u32 s80, s80, s3
    s_lshr_b32 s3, s91, 3
    s_add_u32 s80, s80, s3
    v_add_u32 v58, 4194304, v58
    v_add_u32 v59, 4194304, v59
    s_waitcnt vmcnt(8) lgkmcnt(0)
    s_barrier
    s_cmp_lg_u32 s30, 0
    s_cbranch_scc1 L_noarr1
    s_mov_b32 s75, 0x40000
L_flagchk:
    v_cmp_ne_u32 vcc, 1, v12
    s_cbranch_vccz L_flagok
    global_load_dword v12, v19, s[26:27] sc1
    s_sub_u32 s75, s75, 1
    s_waitcnt vmcnt(0)
    s_cbranch_scc0 L_flagchk
L_flagok:
    s_bfe_u32 s3, s2, 196611
    s_lshl_b32 s3, s3, 8
    s_add_u32 s3, s3, 6422528
    v_mov_b32 v2, 1
    v_lshlrev_b32 v3, 11, v0
    buffer_atomic_add v2, v3, s[64:67], s3 offen sc1
    s_waitcnt vmcnt(1)
    s_branch L_arr1
L_noarr1:
    s_waitcnt vmcnt(0)
L_arr1:
    s_lshl_b32 s74, s30, 12
    s_add_u32 m0, s74, 83200
    s_nop 0
    buffer_load_dwordx4 v14, s[4:7], s28 offen lds
    s_add_u32 s28, s28, 27648
    buffer_load_dwordx4 v14, s[4:7], s28 offen offset:1024 lds
    s_add_u32 s28, s28, 27648
    buffer_load_dwordx4 v14, s[4:7], s28 offen offset:2048 lds
    s_add_u32 s28, s28, 27648
    buffer_load_dwordx4 v14, s[4:7], s28 offen offset:3072 lds
    s_mul_i32 s74, s94, 8320
    s_add_u32 s74, s74, s95
    v_add_u32 v1, s74, v22
    ds_write_b16 v21, v20
    ds_write_b128 v1, v[104:107] offset:4224
    v_alignbit_b32 v120, v104, v100, 16
    v_alignbit_b32 v121, v105, v104, 16
    v_alignbit_b32 v122, v106, v105, 16
    v_alignbit_b32 v123, v107, v106, 16
    ds_write_b128 v1, v[120:123] offset:64
    ds_write_b128 v1, v[108:111] offset:5248
    v_alignbit_b32 v124, v108, v101, 16
    v_alignbit_b32 v125, v109, v108, 16
    v_alignbit_b32 v126, v110, v109, 16
    v_alignbit_b32 v127, v111, v110, 16
    ds_write_b128 v1, v[124:127] offset:1088
    ds_write_b128 v1, v[112:115] offset:6272
    v_alignbit_b32 v120, v112, v102, 16
    v_alignbit_b32 v121, v113, v112, 16
    v_alignbit_b32 v122, v114, v113, 16
    v_alignbit_b32 v123, v115, v114, 16
    ds_write_b128 v1, v[120:123] offset:2112
    ds_write_b128 v1, v[116:119] offset:7296
    v_alignbit_b32 v124, v116, v103, 16
    v_alignbit_b32 v125, v117, v116, 16
    v_alignbit_b32 v126, v118, v117, 16
    v_alignbit_b32 v127, v119, v118, 16
    ds_write_b128 v1, v[124:127] offset:3136
    v_add_u32 v15, 83200, v61
    s_cmp_lg_u32 s30, 0
    s_cbranch_scc1 L_nopoll1
    s_and_b32 s3, s2, 63
    s_mul_i32 s3, s3, 2048
    s_add_u32 s3, s3, 6422528
    s_add_u32 s20, s64, s3
    s_addc_u32 s21, s65, 0
    s_mov_b32 s22, 0x40000
L_poll_1:
    s_load_dword s12, s[20:21], 0 glc
    s_load_dword s13, s[20:21], 256 glc
    s_load_dword s14, s[20:21], 512 glc
    s_load_dword s15, s[20:21], 768 glc
    s_load_dword s16, s[20:21], 1024 glc
    s_load_dword s17, s[20:21], 1280 glc
    s_load_dword s18, s[20:21], 1536 glc
    s_load_dword s19, s[20:21], 1792 glc
    s_sub_u32 s22, s22, 1
    s_waitcnt lgkmcnt(0)
    s_cbranch_scc1 L_polled_1
    s_add_u32 s12, s12, s13
    s_add_u32 s12, s12, s14
    s_add_u32 s12, s12, s15
    s_add_u32 s12, s12, s16
    s_add_u32 s12, s12, s17
    s_add_u32 s12, s12, s18
    s_add_u32 s12, s12, s19
    s_cmp_lg_u32 s12, 256
    s_cbranch_scc1 L_poll_1
L_polled_1:
L_nopoll1:
    s_waitcnt lgkmcnt(0)
    s_barrier
    s_mov_b32 m0, s93
    s_lshl_b32 s3, s94, 3
    s_sub_u32 s3, 8, s3
    buffer_load_dwordx4 v22, s[68:71], s3 offen sc1 lds
    buffer_load_dwordx4 v22, s[68:71], s3 offen offset:1024 sc1 lds
    buffer_load_dwordx4 v22, s[68:71], s3 offen offset:2048 sc1 lds
    buffer_load_dwordx4 v22, s[68:71], s3 offen offset:3072 sc1 lds
    s_mov_b32 s76, 6291456
    ds_read_b128 a[0:3], v8 offset:0
    ds_read_b128 a[4:7], v8 offset:512
    ds_read_b128 a[8:11], v8 offset:1024
    ds_read_b128 a[12:15], v8 offset:1536
    ds_read_b128 a[16:19], v8 offset:2048
    ds_read_b128 a[20:23], v8 offset:2560
    ds_read_b128 a[24:27], v8 offset:3072
    ds_read_b128 a[28:31], v8 offset:3584
    s_lshr_b32 s3, s30, 1
    s_cmp_eq_u32 s3, 0
    s_cselect_b32 s3, 16, 0
    s_lshl_b32 s31, s31, s3
    s_and_b32 s31, s31, 0xffff0000
    s_lshl_b32 s3, s30, 12
    s_add_u32 s74, s3, 66560
    v_add_u32 v11, s74, v22
    s_xor_b32 s3, s3, 4096
    s_add_u32 s74, s3, 66560
    v_add_u32 v12, s74, v22
    v_and_b32 v1, 15, v0
    v_lshlrev_b32 v1, 2, v1
    buffer_load_dwordx2 v[24:25], v5, s[64:67], s77 offen offset:0 sc1
    buffer_load_dwordx2 v[26:27], v5, s[64:67], s77 offen offset:512 sc1
    buffer_load_dwordx2 v[28:29], v5, s[64:67], s77 offen offset:1024 sc1
    buffer_load_dwordx2 v[30:31], v5, s[64:67], s77 offen offset:1536 sc1
    buffer_load_dwordx4 v[96:99], v6, s[64:67], s76 offen offset:0 sc1
    buffer_load_dwordx4 v[100:103], v7, s[64:67], s76 offen offset:0 sc1
    buffer_load_dwordx4 v[104:107], v6, s[64:67], s76 offen offset:1024 sc1
    buffer_load_dwordx4 v[108:111], v7, s[64:67], s76 offen offset:1024 sc1
    buffer_load_dwordx4 v[112:115], v6, s[64:67], s76 offen offset:2048 sc1
    buffer_load_dwordx4 v[116:119], v7, s[64:67], s76 offen offset:2048 sc1
    buffer_load_dwordx4 v[120:123], v6, s[64:67], s76 offen offset:3072 sc1
    buffer_load_dwordx4 v[124:127], v7, s[64:67], s76 offen offset:3072 sc1
    s_waitcnt vmcnt(12)
    s_barrier
    ds_read_b128 a[32:35], v9 offset:3584
    ds_read_b128 a[36:39], v9 offset:3072
    ds_read_b128 a[40:43], v9 offset:2560
    ds_read_b128 a[44:47], v9 offset:2048
    ds_read_b128 a[48:51], v9 offset:1536
    ds_read_b128 a[52:55], v9 offset:1024
    ds_read_b128 a[56:59], v9 offset:512
    ds_read_b128 a[60:63], v9 offset:0
    s_waitcnt lgkmcnt(7)
    v_mfma_f32_16x16x32_bf16 v[64:67], a[0:3], a[32:35], 0
    s_mul_i32 s3, s79, 1792
    v_min_u32 v255, 13, v0
    v_lshlrev_b32 v255, 7, v255
    buffer_load_dword a251, v255, s[56:59], s3 offen
    v_mfma_f32_16x16x32_bf16 v[68:71], a[4:7], a[32:35], 0
    s_waitcnt lgkmcnt(6)
    v_mfma_f32_16x16x32_bf16 v[68:71], a[0:3], a[36:39], v[68:71]
    v_mfma_f32_16x16x32_bf16 v[72:75], a[4:7], a[36:39], 0
    s_add_u32 s81, s80, 0
    s_and_b32 s81, s81, 15
    s_add_u32 m0, s88, 0
    s_mul_i32 s74, s81, 114688
    buffer_load_dwordx4 v56, s[48:51], s74 offen lds
    v_mfma_f32_16x16x32_bf16 v[72:75], a[8:11], a[32:35], v[72:75]
    s_waitcnt lgkmcnt(5)
    v_mfma_f32_16x16x32_bf16 v[72:75], a[0:3], a[40:43], v[72:75]
    v_mfma_f32_16x16x32_bf16 v[76:79], a[8:11], a[36:39], 0
    v_mfma_f32_16x16x32_bf16 v[76:79], a[4:7], a[40:43], v[76:79]
    v_mfma_f32_16x16x32_bf16 v[80:83], a[8:11], a[40:43], 0
    v_mfma_f32_16x16x32_bf16 v[76:79], a[12:15], a[32:35], v[76:79]
    s_waitcnt lgkmcnt(4)
    v_mfma_f32_16x16x32_bf16 v[76:79], a[0:3], a[44:47], v[76:79]
    v_mfma_f32_16x16x32_bf16 v[80:83], a[12:15], a[36:39], v[80:83]
    v_mfma_f32_16x16x32_bf16 v[80:83], a[4:7], a[44:47], v[80:83]
    buffer_load_dwordx4 v56, s[52:55], s74 offen offset:1024 lds
    ds_read_b64 v[32:33], v10 offset:1536
    v_mfma_f32_16x16x32_bf16 v[84:87], a[12:15], a[40:43], 0
    ds_read_b64 v[34:35], v10 offset:1024
    v_mfma_f32_16x16x32_bf16 v[84:87], a[8:11], a[44:47], v[84:87]
    ds_read_b64 v[36:37], v10 offset:512
    v_mfma_f32_16x16x32_bf16 v[88:91], a[12:15], a[44:47], 0
    ds_read_b64 v[38:39], v10 offset:0
    v_mfma_f32_16x16x32_bf16 v[80:83], a[16:19], a[32:35], v[80:83]
    ds_read_b128 a[64:67], v8 offset:64
    s_waitcnt lgkmcnt(8)
    v_mfma_f32_16x16x32_bf16 v[80:83], a[0:3], a[48:51], v[80:83]
    ds_read_b128 a[96:99], v9 offset:3648
    v_mfma_f32_16x16x32_bf16 v[84:87], a[16:19], a[36:39], v[84:87]
    ds_read_b128 a[68:71], v8 offset:576
    v_mfma_f32_16x16x32_bf16 v[84:87], a[4:7], a[48:51], v[84:87]
    ds_read_b128 a[100:103], v9 offset:3136
    v_mfma_f32_16x16x32_bf16 v[88:91], a[16:19], a[40:43], v[88:91]
    ds_read_b128 a[72:75], v8 offset:1088
    v_mfma_f32_16x16x32_bf16 v[88:91], a[8:11], a[48:51], v[88:91]
    ds_read_b128 a[104:107], v9 offset:2624
    v_mfma_f32_16x16x32_bf16 v[92:95], a[16:19], a[44:47], 0
    ds_read_b128 a[76:79], v8 offset:1600
    buffer_load_dwordx4 v57, s[48:51], s74 offen offset:2080 lds
    v_mfma_f32_16x16x32_bf16 v[92:95], a[12:15], a[48:51], v[92:95]
    ds_read_b128 a[108:111], v9 offset:2112
    v_mfma_f32_16x16x32_bf16 v[84:87], a[20:23], a[32:35], v[84:87]
    ds_read_b128 a[80:83], v8 offset:2112
    s_waitcnt lgkmcnt(15)
    v_mfma_f32_16x16x32_bf16 v[84:87], a[0:3], a[52:55], v[84:87]
    ds_read_b128 a[112:115], v9 offset:1600
    v_mfma_f32_16x16x32_bf16 v[88:91], a[20:23], a[36:39], v[88:91]
    ds_read_b128 a[84:87], v8 offset:2624
    v_mfma_f32_16x16x32_bf16 v[88:91], a[4:7], a[52:55], v[88:91]
    ds_read_b128 a[116:119], v9 offset:1088
    v_mfma_f32_16x16x32_bf16 v[92:95], a[20:23], a[40:43], v[92:95]
    ds_read_b128 a[88:91], v8 offset:3136
    v_mfma_f32_16x16x32_bf16 v[92:95], a[8:11], a[52:55], v[92:95]
    ds_read_b128 a[120:123], v9 offset:576
    v_mfma_f32_16x16x32_bf16 v[88:91], a[24:27], a[32:35], v[88:91]
    ds_read_b128 a[92:95], v8 offset:3648
    s_waitcnt lgkmcnt(15)
    v_mfma_f32_16x16x32_bf16 v[88:91], a[0:3], a[56:59], v[88:91]
    ds_read_b128 a[124:127], v9 offset:64
    buffer_load_dwordx4 v57, s[52:55], s74 offen offset:3104 lds
    v_mfma_f32_16x16x32_bf16 v[92:95], a[24:27], a[36:39], v[92:95]
    v_mfma_f32_16x16x32_bf16 v[92:95], a[4:7], a[56:59], v[92:95]
    v_mfma_f32_16x16x32_bf16 v[92:95], a[28:31], a[32:35], v[92:95]
    s_waitcnt lgkmcnt(15)
    v_mfma_f32_16x16x32_bf16 v[92:95], a[0:3], a[60:63], v[92:95]
    s_waitcnt lgkmcnt(14)
    v_mfma_f32_16x16x32_bf16 v[64:67], a[64:67], a[96:99], v[64:67]
    s_waitcnt lgkmcnt(13)
    v_mfma_f32_16x16x32_bf16 v[68:71], a[68:71], a[96:99], v[68:71]
    ds_read_b64_tr_b16 a[128:129], v15 offset:0
    s_waitcnt lgkmcnt(13)
    v_mfma_f32_16x16x32_bf16 v[68:71], a[64:67], a[100:103], v[68:71]
    v_and_b32 v144, 0xffff0000, v33
    v_mfma_f32_16x16x32_bf16 v[72:75], a[68:71], a[100:103], v[72:75]
    v_mul_f32 v144, s31, v144
    ds_read_b64_tr_b16 a[130:131], v15 offset:2048
    s_waitcnt lgkmcnt(13)
    v_mfma_f32_16x16x32_bf16 v[72:75], a[72:75], a[96:99], v[72:75]
    v_lshlrev_b32 v145, 16, v33
    s_waitcnt lgkmcnt(12)
    v_mfma_f32_16x16x32_bf16 v[72:75], a[64:67], a[104:107], v[72:75]
    s_add_u32 s81, s80, 1
    s_and_b32 s81, s81, 15
    s_add_u32 m0, s88, 16640
    s_mul_i32 s74, s81, 114688
    buffer_load_dwordx4 v56, s[48:51], s74 offen lds
    v_mul_f32 v145, s31, v145
    ds_read_b64_tr_b16 a[132:133], v15 offset:4096
    v_mfma_f32_16x16x32_bf16 v[76:79], a[72:75], a[100:103], v[76:79]
    v_and_b32 v146, 0xffff0000, v32
    v_mfma_f32_16x16x32_bf16 v[76:79], a[68:71], a[104:107], v[76:79]
    v_mul_f32 v146, s31, v146
    ds_read_b64_tr_b16 a[134:135], v15 offset:6144
    v_mfma_f32_16x16x32_bf16 v[80:83], a[72:75], a[104:107], v[80:83]
    v_lshlrev_b32 v147, 16, v32
    s_waitcnt lgkmcnt(13)
    v_mfma_f32_16x16x32_bf16 v[76:79], a[76:79], a[96:99], v[76:79]
    v_mul_f32 v147, s31, v147
    ds_read_b64_tr_b16 a[136:137], v15 offset:8192
    s_waitcnt lgkmcnt(13)
    v_mfma_f32_16x16x32_bf16 v[76:79], a[64:67], a[108:111], v[76:79]
    v_and_b32 v148, 0xffff0000, v35
    v_mfma_f32_16x16x32_bf16 v[80:83], a[76:79], a[100:103], v[80:83]
    v_mul_f32 v148, s31, v148
    ds_read_b64_tr_b16 a[138:139], v15 offset:10240
    v_mfma_f32_16x16x32_bf16 v[80:83], a[68:71], a[108:111], v[80:83]
    v_lshlrev_b32 v149, 16, v35
    v_mfma_f32_16x16x32_bf16 v[84:87], a[76:79], a[104:107], v[84:87]
    v_mul_f32 v149, s31, v149
    ds_read_b64_tr_b16 a[140:141], v15 offset:12288
    v_mfma_f32_16x16x32_bf16 v[84:87], a[72:75], a[108:111], v[84:87]
    v_and_b32 v150, 0xffff0000, v34
    v_mfma_f32_16x16x32_bf16 v[88:91], a[76:79], a[108:111], v[88:91]
    buffer_load_dwordx4 v56, s[52:55], s74 offen offset:1024 lds
    v_mul_f32 v150, s31, v150
    ds_read_b64_tr_b16 a[142:143], v15 offset:14336
    s_waitcnt lgkmcnt(15)
    v_mfma_f32_16x16x32_bf16 v[80:83], a[80:83], a[96:99], v[80:83]
    ds_read_b128 a[0:3], v8 offset:128
    v_lshlrev_b32 v151, 16, v34
    s_waitcnt lgkmcnt(15)
    v_mfma_f32_16x16x32_bf16 v[80:83], a[64:67], a[112:115], v[80:83]
    ds_read_b128 a[32:35], v9 offset:3712
    v_mul_f32 v151, s31, v151
    v_mfma_f32_16x16x32_bf16 v[84:87], a[80:83], a[100:103], v[84:87]
    ds_read_b128 a[4:7], v8 offset:640
    v_and_b32 v152, 0xffff0000, v37
    v_mfma_f32_16x16x32_bf16 v[84:87], a[68:71], a[112:115], v[84:87]
    ds_read_b128 a[36:39], v9 offset:3200
    v_mul_f32 v152, s31, v152
    v_mfma_f32_16x16x32_bf16 v[88:91], a[80:83], a[104:107], v[88:91]
    ds_read_b128 a[8:11], v8 offset:1152
    v_lshlrev_b32 v153, 16, v37
    v_mfma_f32_16x16x32_bf16 v[88:91], a[72:75], a[112:115], v[88:91]
    ds_read_b128 a[40:43], v9 offset:2688
    v_mul_f32 v153, s31, v153
    v_mfma_f32_16x16x32_bf16 v[92:95], a[80:83], a[108:111], v[92:95]
    ds_read_b128 a[12:15], v8 offset:1664
    v_and_b32 v154, 0xffff0000, v36
    v_mfma_f32_16x16x32_bf16 v[92:95], a[76:79], a[112:115], v[92:95]
    ds_read_b128 a[44:47], v9 offset:2176
    v_mul_f32 v154, s31, v154
    s_waitcnt lgkmcnt(15)
    v_mfma_f32_16x16x32_bf16 v[84:87], a[84:87], a[96:99], v[84:87]
    ds_read_b128 a[16:19], v8 offset:2176
    buffer_load_dwordx4 v57, s[48:51], s74 offen offset:2080 lds
    v_lshlrev_b32 v155, 16, v36
    s_waitcnt lgkmcnt(15)
    v_mfma_f32_16x16x32_bf16 v[84:87], a[64:67], a[116:119], v[84:87]
    ds_read_b128 a[48:51], v9 offset:1664
    v_mul_f32 v155, s31, v155
    v_mfma_f32_16x16x32_bf16 v[88:91], a[84:87], a[100:103], v[88:91]
    ds_read_b128 a[20:23], v8 offset:2688
    v_and_b32 v156, 0xffff0000, v39
    v_mfma_f32_16x16x32_bf16 v[88:91], a[68:71], a[116:119], v[88:91]
    ds_read_b128 a[52:55], v9 offset:1152
    v_mul_f32 v156, s31, v156
    v_mfma_f32_16x16x32_bf16 v[92:95], a[84:87], a[104:107], v[92:95]
    ds_read_b128 a[24:27], v8 offset:3200
    v_lshlrev_b32 v157, 16, v39
    v_mfma_f32_16x16x32_bf16 v[92:95], a[72:75], a[116:119], v[92:95]
    ds_read_b128 a[56:59], v9 offset:640
    v_mul_f32 v157, s31, v157
    s_waitcnt lgkmcnt(15)
    v_mfma_f32_16x16x32_bf16 v[88:91], a[88:91], a[96:99], v[88:91]
    ds_read_b128 a[28:31], v8 offset:3712
    v_and_b32 v158, 0xffff0000, v38
    s_waitcnt lgkmcnt(15)
    v_mfma_f32_16x16x32_bf16 v[88:91], a[64:67], a[120:123], v[88:91]
    ds_read_b128 a[60:63], v9 offset:128
    v_mul_f32 v158, s31, v158
    v_mfma_f32_16x16x32_bf16 v[92:95], a[88:91], a[100:103], v[92:95]
    v_lshlrev_b32 v159, 16, v38
    v_mfma_f32_16x16x32_bf16 v[92:95], a[68:71], a[120:123], v[92:95]
    v_mul_f32 v159, s31, v159
    s_waitcnt lgkmcnt(15)
    v_mfma_f32_16x16x32_bf16 v[92:95], a[92:95], a[96:99], v[92:95]
    buffer_load_dwordx4 v57, s[52:55], s74 offen offset:3104 lds
    s_waitcnt lgkmcnt(15)
    v_mfma_f32_16x16x32_bf16 v[92:95], a[64:67], a[124:127], v[92:95]
    s_waitcnt lgkmcnt(14)
    v_mfma_f32_16x16x32_bf16 v[64:67], a[0:3], a[32:35], v[64:67]
    s_waitcnt lgkmcnt(13)
    v_mfma_f32_16x16x32_bf16 v[68:71], a[4:7], a[32:35], v[68:71]
    v_mfma_f32_16x16x32_bf16 v[16:19], a[252:255], a[128:131], 0
    s_waitcnt lgkmcnt(12)
    v_mfma_f32_16x16x32_bf16 v[68:71], a[0:3], a[36:39], v[68:71]
    v_mfma_f32_16x16x32_bf16 v[72:75], a[4:7], a[36:39], v[72:75]
    v_mfma_f32_16x16x32_bf16 v[16:19], a[252:255], a[132:135], v[16:19]
    s_waitcnt lgkmcnt(11)
    v_mfma_f32_16x16x32_bf16 v[72:75], a[8:11], a[32:35], v[72:75]
    s_waitcnt lgkmcnt(10)
    v_mfma_f32_16x16x32_bf16 v[72:75], a[0:3], a[40:43], v[72:75]
    v_mfma_f32_16x16x32_bf16 v[16:19], a[252:255], a[136:139], v[16:19]
    v_mfma_f32_16x16x32_bf16 v[76:79], a[8:11], a[36:39], v[76:79]
    v_mfma_f32_16x16x32_bf16 v[76:79], a[4:7], a[40:43], v[76:79]
    v_mfma_f32_16x16x32_bf16 v[16:19], a[252:255], a[140:143], v[16:19]
    v_mfma_f32_16x16x32_bf16 v[80:83], a[8:11], a[40:43], v[80:83]
    s_waitcnt vmcnt(9)
    v_lshlrev_b32 v160, 16, v24
    s_waitcnt lgkmcnt(9)
    v_mfma_f32_16x16x32_bf16 v[76:79], a[12:15], a[32:35], v[76:79]
    v_sub_f32 v128, v160, v96
    s_waitcnt lgkmcnt(8)
    v_mfma_f32_16x16x32_bf16 v[76:79], a[0:3], a[44:47], v[76:79]
    v_mul_f32 v128, v128, v100
    v_mfma_f32_16x16x32_bf16 v[80:83], a[12:15], a[36:39], v[80:83]
    v_fma_f32 v144, v128, v144, v160
    v_mfma_f32_16x16x32_bf16 v[80:83], a[4:7], a[44:47], v[80:83]
    v_and_b32 v161, 0xffff0000, v24
    v_mfma_f32_16x16x32_bf16 v[84:87], a[12:15], a[40:43], v[84:87]
    v_sub_f32 v129, v161, v97
    v_mfma_f32_16x16x32_bf16 v[84:87], a[8:11], a[44:47], v[84:87]
    v_mul_f32 v129, v129, v101
    v_mfma_f32_16x16x32_bf16 v[88:91], a[12:15], a[44:47], v[88:91]
    buffer_store_dword v16, v1, s[64:67], s92 offen sc1
    v_fma_f32 v145, v129, v145, v161
    s_waitcnt lgkmcnt(7)
    v_mfma_f32_16x16x32_bf16 v[80:83], a[16:19], a[32:35], v[80:83]
    ds_read_b128 a[64:67], v8 offset:192
    v_lshlrev_b32 v162, 16, v25
    s_waitcnt lgkmcnt(7)
    v_mfma_f32_16x16x32_bf16 v[80:83], a[0:3], a[48:51], v[80:83]
    ds_read_b128 a[96:99], v9 offset:3776
    v_sub_f32 v130, v162, v98
    v_mfma_f32_16x16x32_bf16 v[84:87], a[16:19], a[36:39], v[84:87]
    ds_read_b128 a[68:71], v8 offset:704
    v_mul_f32 v130, v130, v102
    v_mfma_f32_16x16x32_bf16 v[84:87], a[4:7], a[48:51], v[84:87]
    ds_read_b128 a[100:103], v9 offset:3264
    v_fma_f32 v146, v130, v146, v162
    v_mfma_f32_16x16x32_bf16 v[88:91], a[16:19], a[40:43], v[88:91]
    ds_read_b128 a[72:75], v8 offset:1216
    v_and_b32 v163, 0xffff0000, v25
    v_mfma_f32_16x16x32_bf16 v[88:91], a[8:11], a[48:51], v[88:91]
    ds_read_b128 a[104:107], v9 offset:2752
    v_sub_f32 v131, v163, v99
    v_mfma_f32_16x16x32_bf16 v[92:95], a[16:19], a[44:47], v[92:95]
    ds_read_b128 a[76:79], v8 offset:1728
    v_mul_f32 v131, v131, v103
    v_mfma_f32_16x16x32_bf16 v[92:95], a[12:15], a[48:51], v[92:95]
    ds_read_b128 a[108:111], v9 offset:2240
    v_fma_f32 v147, v131, v147, v163
    s_waitcnt lgkmcnt(13)
    v_mfma_f32_16x16x32_bf16 v[84:87], a[20:23], a[32:35], v[84:87]
    ds_read_b128 a[80:83], v8 offset:2240
    v_lshlrev_b32 v164, 16, v26
    s_waitcnt lgkmcnt(13)
    v_mfma_f32_16x16x32_bf16 v[84:87], a[0:3], a[52:55], v[84:87]
    ds_read_b128 a[112:115], v9 offset:1728
    v_sub_f32 v132, v164, v104
    v_mfma_f32_16x16x32_bf16 v[88:91], a[20:23], a[36:39], v[88:91]
    ds_read_b128 a[84:87], v8 offset:2752
    v_mul_f32 v132, v132, v108
    v_mfma_f32_16x16x32_bf16 v[88:91], a[4:7], a[52:55], v[88:91]
    ds_read_b128 a[116:119], v9 offset:1216
    v_fma_f32 v148, v132, v148, v164
    v_mfma_f32_16x16x32_bf16 v[92:95], a[20:23], a[40:43], v[92:95]
    ds_read_b128 a[88:91], v8 offset:3264
    v_and_b32 v165, 0xffff0000, v26
    v_mfma_f32_16x16x32_bf16 v[92:95], a[8:11], a[52:55], v[92:95]
    ds_read_b128 a[120:123], v9 offset:704
    v_sub_f32 v133, v165, v105
    s_waitcnt lgkmcnt(15)
    v_mfma_f32_16x16x32_bf16 v[88:91], a[24:27], a[32:35], v[88:91]
    ds_read_b128 a[92:95], v8 offset:3776
    v_mul_f32 v133, v133, v109
    s_waitcnt lgkmcnt(15)
    v_mfma_f32_16x16x32_bf16 v[88:91], a[0:3], a[56:59], v[88:91]
    ds_read_b128 a[124:127], v9 offset:192
    v_fma_f32 v149, v133, v149, v165
    v_mfma_f32_16x16x32_bf16 v[92:95], a[24:27], a[36:39], v[92:95]
    v_lshlrev_b32 v166, 16, v27
    v_mfma_f32_16x16x32_bf16 v[92:95], a[4:7], a[56:59], v[92:95]
    v_sub_f32 v134, v166, v106
    s_waitcnt lgkmcnt(15)
    v_mfma_f32_16x16x32_bf16 v[92:95], a[28:31], a[32:35], v[92:95]
    v_mul_f32 v134, v134, v110
    s_waitcnt lgkmcnt(15)
    v_mfma_f32_16x16x32_bf16 v[92:95], a[0:3], a[60:63], v[92:95]
    v_fma_f32 v150, v134, v150, v166
    s_cmp_eq_u32 s94, 1
    s_cbranch_scc1 L_ctail1
    s_waitcnt lgkmcnt(10)
    v_mfma_f32_16x16x32_bf16 v[80:83], a[72:75], a[104:107], v[80:83]
    v_and_b32 v167, 0xffff0000, v27
    v_sub_f32 v135, v167, v107
    s_waitcnt lgkmcnt(8)
    v_mfma_f32_16x16x32_bf16 v[84:87], a[72:75], a[108:111], v[84:87]
    v_mul_f32 v135, v135, v111
    v_fma_f32 v151, v135, v151, v167
    v_mfma_f32_16x16x32_bf16 v[88:91], a[76:79], a[108:111], v[88:91]
    v_lshlrev_b32 v168, 16, v28
    v_sub_f32 v136, v168, v112
    s_waitcnt lgkmcnt(6)
    v_mfma_f32_16x16x32_bf16 v[92:95], a[76:79], a[112:115], v[92:95]
    v_mul_f32 v136, v136, v116
    v_fma_f32 v152, v136, v152, v168
    v_mfma_f32_16x16x32_bf16 v[80:83], a[68:71], a[108:111], v[80:83]
    v_and_b32 v169, 0xffff0000, v28
    v_sub_f32 v137, v169, v113
    v_mfma_f32_16x16x32_bf16 v[84:87], a[76:79], a[104:107], v[84:87]
    v_mul_f32 v137, v137, v117
    v_fma_f32 v153, v137, v153, v169
    v_mfma_f32_16x16x32_bf16 v[88:91], a[72:75], a[112:115], v[88:91]
    v_lshlrev_b32 v170, 16, v29
    v_sub_f32 v138, v170, v114
    v_mfma_f32_16x16x32_bf16 v[92:95], a[80:83], a[108:111], v[92:95]
    v_mul_f32 v138, v138, v118
    v_fma_f32 v154, v138, v154, v170
    v_mfma_f32_16x16x32_bf16 v[88:91], a[80:83], a[104:107], v[88:91]
    v_and_b32 v171, 0xffff0000, v29
    v_sub_f32 v139, v171, v115
    s_waitcnt lgkmcnt(4)
    v_mfma_f32_16x16x32_bf16 v[92:95], a[72:75], a[116:119], v[92:95]
    v_mul_f32 v139, v139, v119
    v_fma_f32 v155, v139, v155, v171
    v_mfma_f32_16x16x32_bf16 v[84:87], a[68:71], a[112:115], v[84:87]
    v_lshlrev_b32 v172, 16, v30
    v_sub_f32 v140, v172, v120
    v_mfma_f32_16x16x32_bf16 v[88:91], a[68:71], a[116:119], v[88:91]
    v_mul_f32 v140, v140, v124
    v_fma_f32 v156, v140, v156, v172
    v_mfma_f32_16x16x32_bf16 v[92:95], a[84:87], a[104:107], v[92:95]
    v_and_b32 v173, 0xffff0000, v30
    v_sub_f32 v141, v173, v121
    v_mfma_f32_16x16x32_bf16 v[80:83], a[76:79], a[100:103], v[80:83]
    v_mul_f32 v141, v141, v125
    v_fma_f32 v157, v141, v157, v173
    v_mfma_f32_16x16x32_bf16 v[84:87], a[80:83], a[100:103], v[84:87]
    v_lshlrev_b32 v174, 16, v31
    v_sub_f32 v142, v174, v122
    v_mfma_f32_16x16x32_bf16 v[88:91], a[84:87], a[100:103], v[88:91]
    v_mul_f32 v142, v142, v126
    v_fma_f32 v158, v142, v158, v174
    s_waitcnt lgkmcnt(2)
    v_mfma_f32_16x16x32_bf16 v[92:95], a[68:71], a[120:123], v[92:95]
    v_and_b32 v175, 0xffff0000, v31
    v_sub_f32 v143, v175, v123
    v_mfma_f32_16x16x32_bf16 v[80:83], a[64:67], a[112:115], v[80:83]
    v_mul_f32 v143, v143, v127
    v_fma_f32 v159, v143, v159, v175
    v_mfma_f32_16x16x32_bf16 v[84:87], a[64:67], a[116:119], v[84:87]
    v_mfma_f32_16x16x32_bf16 v[88:91], a[64:67], a[120:123], v[88:91]
    v_mfma_f32_16x16x32_bf16 v[92:95], a[88:91], a[100:103], v[92:95]
    v_mfma_f32_16x16x32_bf16 v[80:83], a[80:83], a[96:99], v[80:83]
    v_mfma_f32_16x16x32_bf16 v[84:87], a[84:87], a[96:99], v[84:87]
    v_mfma_f32_16x16x32_bf16 v[88:91], a[88:91], a[96:99], v[88:91]
    s_waitcnt lgkmcnt(0)
    v_mfma_f32_16x16x32_bf16 v[92:95], a[64:67], a[124:127], v[92:95]
    v_mfma_f32_16x16x32_bf16 v[92:95], a[92:95], a[96:99], v[92:95]
    v_mfma_f32_16x16x32_bf16 v[64:67], a[64:67], a[96:99], v[64:67]
    v_mfma_f32_16x16x32_bf16 v[68:71], a[64:67], a[100:103], v[68:71]
    v_mfma_f32_16x16x32_bf16 v[72:75], a[68:71], a[100:103], v[72:75]
    ds_write_b128 v11, v[80:83] offset:0
    v_mfma_f32_16x16x32_bf16 v[76:79], a[68:71], a[104:107], v[76:79]
    ds_write_b128 v11, v[84:87] offset:1024
    v_mfma_f32_16x16x32_bf16 v[68:71], a[68:71], a[96:99], v[68:71]
    ds_write_b128 v11, v[88:91] offset:2048
    v_mfma_f32_16x16x32_bf16 v[72:75], a[64:67], a[104:107], v[72:75]
    ds_write_b128 v11, v[92:95] offset:3072
    v_mfma_f32_16x16x32_bf16 v[76:79], a[72:75], a[100:103], v[76:79]
    v_mfma_f32_16x16x32_bf16 v[72:75], a[72:75], a[96:99], v[72:75]
    v_mfma_f32_16x16x32_bf16 v[76:79], a[64:67], a[108:111], v[76:79]
    v_mfma_f32_16x16x32_bf16 v[76:79], a[76:79], a[96:99], v[76:79]
    s_waitcnt lgkmcnt(0)
    s_barrier
    ds_read_b128 v[176:179], v12 offset:0
    ds_read_b128 v[180:183], v12 offset:1024
    ds_read_b128 v[184:187], v12 offset:2048
    ds_read_b128 v[188:191], v12 offset:3072
    s_nop 3
    v_pk_fma_f32 v[144:145], v[128:129], v[64:65], v[144:145]
    v_pk_fma_f32 v[146:147], v[130:131], v[66:67], v[146:147]
    v_pk_fma_f32 v[148:149], v[132:133], v[68:69], v[148:149]
    v_pk_fma_f32 v[150:151], v[134:135], v[70:71], v[150:151]
    v_pk_fma_f32 v[152:153], v[136:137], v[72:73], v[152:153]
    v_pk_fma_f32 v[154:155], v[138:139], v[74:75], v[154:155]
    v_pk_fma_f32 v[156:157], v[140:141], v[76:77], v[156:157]
    v_pk_fma_f32 v[158:159], v[142:143], v[78:79], v[158:159]
    s_branch L_ctail2
L_ctail1:
    s_waitcnt lgkmcnt(14)
    v_mfma_f32_16x16x32_bf16 v[64:67], a[64:67], a[96:99], v[64:67]
    v_and_b32 v167, 0xffff0000, v27
    v_sub_f32 v135, v167, v107
    s_waitcnt lgkmcnt(12)
    v_mfma_f32_16x16x32_bf16 v[68:71], a[64:67], a[100:103], v[68:71]
    v_mul_f32 v135, v135, v111
    v_fma_f32 v151, v135, v151, v167
    v_mfma_f32_16x16x32_bf16 v[72:75], a[68:71], a[100:103], v[72:75]
    v_lshlrev_b32 v168, 16, v28
    v_sub_f32 v136, v168, v112
    s_waitcnt lgkmcnt(10)
    v_mfma_f32_16x16x32_bf16 v[76:79], a[68:71], a[104:107], v[76:79]
    v_mul_f32 v136, v136, v116
    v_fma_f32 v152, v136, v152, v168
    v_mfma_f32_16x16x32_bf16 v[68:71], a[68:71], a[96:99], v[68:71]
    v_and_b32 v169, 0xffff0000, v28
    v_sub_f32 v137, v169, v113
    v_mfma_f32_16x16x32_bf16 v[72:75], a[64:67], a[104:107], v[72:75]
    v_mul_f32 v137, v137, v117
    v_fma_f32 v153, v137, v153, v169
    v_mfma_f32_16x16x32_bf16 v[76:79], a[72:75], a[100:103], v[76:79]
    v_lshlrev_b32 v170, 16, v29
    v_sub_f32 v138, v170, v114
    v_mfma_f32_16x16x32_bf16 v[72:75], a[72:75], a[96:99], v[72:75]
    v_mul_f32 v138, v138, v118
    v_fma_f32 v154, v138, v154, v170
    s_waitcnt lgkmcnt(8)
    v_mfma_f32_16x16x32_bf16 v[76:79], a[64:67], a[108:111], v[76:79]
    v_and_b32 v171, 0xffff0000, v29
    v_sub_f32 v139, v171, v115
    v_mfma_f32_16x16x32_bf16 v[76:79], a[76:79], a[96:99], v[76:79]
    v_mul_f32 v139, v139, v119
    v_fma_f32 v155, v139, v155, v171
    v_mfma_f32_16x16x32_bf16 v[80:83], a[72:75], a[104:107], v[80:83]
    v_lshlrev_b32 v172, 16, v30
    v_sub_f32 v140, v172, v120
    v_mfma_f32_16x16x32_bf16 v[84:87], a[72:75], a[108:111], v[84:87]
    v_mul_f32 v140, v140, v124
    v_fma_f32 v156, v140, v156, v172
    v_mfma_f32_16x16x32_bf16 v[88:91], a[76:79], a[108:111], v[88:91]
    ds_write_b128 v11, v[64:67] offset:0
    s_waitcnt lgkmcnt(7)
    v_mfma_f32_16x16x32_bf16 v[92:95], a[76:79], a[112:115], v[92:95]
    ds_write_b128 v11, v[68:71] offset:1024
    v_mfma_f32_16x16x32_bf16 v[80:83], a[68:71], a[108:111], v[80:83]
    ds_write_b128 v11, v[72:75] offset:2048
    v_mfma_f32_16x16x32_bf16 v[84:87], a[76:79], a[104:107], v[84:87]
    ds_write_b128 v11, v[76:79] offset:3072
    v_mfma_f32_16x16x32_bf16 v[88:91], a[72:75], a[112:115], v[88:91]
    v_and_b32 v173, 0xffff0000, v30
    v_sub_f32 v141, v173, v121
    v_mfma_f32_16x16x32_bf16 v[92:95], a[80:83], a[108:111], v[92:95]
    v_mul_f32 v141, v141, v125
    v_fma_f32 v157, v141, v157, v173
    v_mfma_f32_16x16x32_bf16 v[88:91], a[80:83], a[104:107], v[88:91]
    v_lshlrev_b32 v174, 16, v31
    v_sub_f32 v142, v174, v122
    s_waitcnt lgkmcnt(8)
    v_mfma_f32_16x16x32_bf16 v[92:95], a[72:75], a[116:119], v[92:95]
    v_mul_f32 v142, v142, v126
    v_fma_f32 v158, v142, v158, v174
    v_mfma_f32_16x16x32_bf16 v[84:87], a[68:71], a[112:115], v[84:87]
    v_and_b32 v175, 0xffff0000, v31
    v_sub_f32 v143, v175, v123
    v_mfma_f32_16x16x32_bf16 v[88:91], a[68:71], a[116:119], v[88:91]
    v_mul_f32 v143, v143, v127
    v_fma_f32 v159, v143, v159, v175
    v_mfma_f32_16x16x32_bf16 v[92:95], a[84:87], a[104:107], v[92:95]
    v_mfma_f32_16x16x32_bf16 v[80:83], a[76:79], a[100:103], v[80:83]
    v_mfma_f32_16x16x32_bf16 v[84:87], a[80:83], a[100:103], v[84:87]
    v_mfma_f32_16x16x32_bf16 v[88:91], a[84:87], a[100:103], v[88:91]
    s_waitcnt lgkmcnt(6)
    v_mfma_f32_16x16x32_bf16 v[92:95], a[68:71], a[120:123], v[92:95]
    v_mfma_f32_16x16x32_bf16 v[80:83], a[64:67], a[112:115], v[80:83]
    v_mfma_f32_16x16x32_bf16 v[84:87], a[64:67], a[116:119], v[84:87]
    v_mfma_f32_16x16x32_bf16 v[88:91], a[64:67], a[120:123], v[88:91]
    v_mfma_f32_16x16x32_bf16 v[92:95], a[88:91], a[100:103], v[92:95]
    v_mfma_f32_16x16x32_bf16 v[80:83], a[80:83], a[96:99], v[80:83]
    v_mfma_f32_16x16x32_bf16 v[84:87], a[84:87], a[96:99], v[84:87]
    v_mfma_f32_16x16x32_bf16 v[88:91], a[88:91], a[96:99], v[88:91]
    s_waitcnt lgkmcnt(4)
    v_mfma_f32_16x16x32_bf16 v[92:95], a[64:67], a[124:127], v[92:95]
    v_mfma_f32_16x16x32_bf16 v[92:95], a[92:95], a[96:99], v[92:95]
    s_waitcnt lgkmcnt(0)
    s_barrier
    ds_read_b128 v[176:179], v12 offset:0
    ds_read_b128 v[180:183], v12 offset:1024
    ds_read_b128 v[184:187], v12 offset:2048
    ds_read_b128 v[188:191], v12 offset:3072
    s_nop 3
    v_pk_fma_f32 v[144:145], v[128:129], v[80:81], v[144:145]
    v_pk_fma_f32 v[146:147], v[130:131], v[82:83], v[146:147]
    v_pk_fma_f32 v[148:149], v[132:133], v[84:85], v[148:149]
    v_pk_fma_f32 v[150:151], v[134:135], v[86:87], v[150:151]
    v_pk_fma_f32 v[152:153], v[136:137], v[88:89], v[152:153]
    v_pk_fma_f32 v[154:155], v[138:139], v[90:91], v[154:155]
    v_pk_fma_f32 v[156:157], v[140:141], v[92:93], v[156:157]
    v_pk_fma_f32 v[158:159], v[142:143], v[94:95], v[158:159]
L_ctail2:
    s_waitcnt lgkmcnt(3)
    v_pk_fma_f32 v[144:145], v[128:129], v[176:177], v[144:145]
    v_pk_fma_f32 v[146:147], v[130:131], v[178:179], v[146:147]
    v_cvt_pk_bf16_f32 v48, v144, v145
    v_cvt_pk_bf16_f32 v49, v146, v147
    buffer_store_dwordx2 v[48:49], v13, s[64:67], s78 offen sc1
    s_add_u32 s78, s78, 262144
    s_waitcnt lgkmcnt(2)
    v_pk_fma_f32 v[148:149], v[132:133], v[180:181], v[148:149]
    v_pk_fma_f32 v[150:151], v[134:135], v[182:183], v[150:151]
    v_cvt_pk_bf16_f32 v50, v148, v149
    v_cvt_pk_bf16_f32 v51, v150, v151
    buffer_store_dwordx2 v[50:51], v13, s[64:67], s78 offen sc1
    s_add_u32 s78, s78, 262144
    s_waitcnt lgkmcnt(1)
    v_pk_fma_f32 v[152:153], v[136:137], v[184:185], v[152:153]
    v_pk_fma_f32 v[154:155], v[138:139], v[186:187], v[154:155]
    v_cvt_pk_bf16_f32 v52, v152, v153
    v_cvt_pk_bf16_f32 v53, v154, v155
    buffer_store_dwordx2 v[52:53], v13, s[64:67], s78 offen sc1
    s_add_u32 s78, s78, 262144
    s_waitcnt lgkmcnt(0)
    v_pk_fma_f32 v[156:157], v[140:141], v[188:189], v[156:157]
    v_pk_fma_f32 v[158:159], v[142:143], v[190:191], v[158:159]
    v_cvt_pk_bf16_f32 v54, v156, v157
    v_cvt_pk_bf16_f32 v55, v158, v159
    buffer_store_dwordx2 v[54:55], v13, s[64:67], s78 offen sc1
    s_add_u32 s78, s78, 262144
    s_nop 1
    s_lshr_b32 s82, s30, 1
    s_and_b32 s3, s91, 1
    s_xor_b32 s3, s3, s82
    s_xor_b32 s3, s3, 1
    s_lshl_b32 s83, s82, 1
    s_add_u32 s83, s83, s3
    v_bfe_u32 v1, v0, 2, 3
    v_lshrrev_b32 v2, 5, v0
    v_lshlrev_b32 v2, 8, v2
    v_and_b32 v3, 3, v0
    v_lshl_add_u32 v2, v3, 3, v2
    v_mul_u32_u24 v8, 2080, v1
    v_add_u32 v8, v8, v2
    v_add_u32 v11, 192, v8
    v_add_u32 v12, 49920, v11
    s_mul_i32 s3, s82, 96
    v_add_u32 v8, s3, v8
    v_add_u32 v9, 49920, v8
    v_mul_u32_u24 v10, 1056, v1
    v_add_u32 v10, v10, v2
    s_lshl_b32 s74, s94, 7
    s_add_u32 s74, s74, 99840
    s_xor_b32 s3, s83, 0
    s_lshl_b32 s3, s3, 5
    s_add_u32 s3, s3, s74
    v_add_u32 v14, s3, v10
    s_xor_b32 s3, s83, 1
    s_lshl_b32 s3, s3, 5
    s_add_u32 s3, s3, s74
    v_add_u32 v15, s3, v10
    s_xor_b32 s3, s83, 2
    s_lshl_b32 s3, s3, 5
    s_add_u32 s3, s3, s74
    v_add_u32 v16, s3, v10
    s_xor_b32 s3, s83, 3
    s_lshl_b32 s3, s3, 5
    s_add_u32 s3, s3, s74
    v_add_u32 v17, s3, v10
    s_lshl_b32 s3, s30, 6
    v_add_u32 v1, s3, v0
    v_min_u32 v1, 223, v1
    v_lshlrev_b32 v13, 2, v1
    v_add_u32 v13, 151680, v13
    v_cmp_le_u32 vcc, 112, v1
    v_add_u32 v2, 1680, v1
    s_nop 0
    v_cndmask_b32 v1, v1, v2, vcc
    s_mul_i32 s3, s91, 112
    v_add_u32 v1, s3, v1
    v_lshlrev_b32 v23, 2, v1
    v_add_u32 v23, 6356992, v23
    v_and_b32 v1, 3, v0
    v_cmp_eq_u32 s[4:5], 1, v1
    v_cmp_eq_u32 s[6:7], 2, v1
    v_cmp_eq_u32 s[8:9], 3, v1
    v_bfe_u32 v1, v0, 2, 2
    v_lshrrev_b32 v2, 4, v0
    v_cmp_eq_u32 s[10:11], v1, v2
    s_lshl_b32 s24, s90, 1
    s_add_u32 s24, s24, s94
    s_lshl_b32 s3, s94, 2
    s_add_u32 s3, s3, s83
    s_lshl_b32 s3, s3, 7
    s_lshl_b32 s74, s90, 14
    s_add_u32 s3, s3, s74
    s_add_u32 s3, s3, 7340032
    v_lshrrev_b32 v1, 3, v0
    v_lshlrev_b32 v19, 10, v1
    v_and_b32 v1, 7, v0
    v_lshl_add_u32 v19, v1, 4, v19
    v_add_u32 v19, s3, v19
    s_lshl_b32 s74, s91, 10
    s_add_u32 s3, s3, s74
    v_and_b32 v1, 15, v0
    v_lshlrev_b32 v18, 3, v1
    v_add_u32 v18, s3, v18
    s_lshl_b32 s3, s94, 2
    s_add_u32 s3, s3, s83
    s_lshl_b32 s3, s3, 7
    s_add_u32 s3, s3, 152576
    v_lshlrev_b32 v20, 3, v1
    v_add_u32 v20, s3, v20
    v_lshlrev_b32 v21, 4, v2
    v_add_u32 v21, 151680, v21
    v_and_b32 v1, 7, v0
    v_lshlrev_b32 v1, 4, v1
    v_and_b32 v3, 1, v2
    v_lshl_add_u32 v1, v3, 3, v1
    v_add_u32 v1, s3, v1
    v_lshrrev_b32 v3, 5, v0
    v_lshlrev_b32 v3, 7, v3
    v_xor_b32 v10, v1, v3
    s_and_b32 s3, s2, 7
    s_lshl_b32 s84, s3, 2
    s_bfe_u32 s3, s2, 0x20003
    s_add_u32 s84, s84, s3
    s_lshr_b32 s85, s2, 5
    s_lshl_b32 s74, s30, 1
    s_bfe_u32 s3, s85, 0x10001
    s_add_u32 s25, s74, s3
    s_mul_i32 s86, s25, 229376
    s_xor_b32 s3, s25, 1
    s_mul_i32 s87, s3, 229376
    s_lshl_b32 s3, s85, 7
    s_add_u32 s86, s86, s3
    s_add_u32 s87, s87, s3
    v_xor_b32 v1, 0, v61
    v_add_u32 v44, s88, v1
    v_add_u32 v48, 49920, v44
    v_add_u32 v52, s89, v1
    v_xor_b32 v1, 32, v61
    v_add_u32 v45, s88, v1
    v_add_u32 v49, 49920, v45
    v_add_u32 v53, s89, v1
    v_xor_b32 v1, 64, v61
    v_add_u32 v46, s88, v1
    v_add_u32 v50, 49920, v46
    v_add_u32 v54, s89, v1
    v_xor_b32 v1, 96, v61
    v_add_u32 v47, s88, v1
    v_add_u32 v51, 49920, v47
    v_add_u32 v55, s89, v1
    s_waitcnt vmcnt(0)
    s_barrier
    s_cmp_lg_u32 s30, 0
    s_cbranch_scc1 L_noarr2
    s_bfe_u32 s3, s2, 196611
    s_lshl_b32 s3, s3, 8
    s_add_u32 s3, s3, 6553600
    v_mov_b32 v2, 1
    v_lshlrev_b32 v3, 11, v0
    buffer_atomic_add v2, v3, s[64:67], s3 offen sc1
L_noarr2:
    s_add_u32 s81, s80, 2
    s_and_b32 s81, s81, 15
    s_add_u32 m0, s88, 33280
    s_mul_i32 s74, s81, 114688
    buffer_load_dwordx4 v56, s[48:51], s74 offen lds
    buffer_load_dwordx4 v56, s[52:55], s74 offen offset:1024 lds
    buffer_load_dwordx4 v57, s[48:51], s74 offen offset:2080 lds
    buffer_load_dwordx4 v57, s[52:55], s74 offen offset:3104 lds
    s_add_u32 s81, s80, 3
    s_and_b32 s81, s81, 15
    s_add_u32 m0, s88, 49920
    s_mul_i32 s74, s81, 114688
    buffer_load_dwordx4 v56, s[48:51], s74 offen lds
    buffer_load_dwordx4 v56, s[52:55], s74 offen offset:1024 lds
    buffer_load_dwordx4 v57, s[48:51], s74 offen offset:2080 lds
    buffer_load_dwordx4 v57, s[52:55], s74 offen offset:3104 lds
    s_add_u32 s81, s80, 4
    s_and_b32 s81, s81, 15
    s_add_u32 m0, s88, 66560
    s_mul_i32 s74, s81, 114688
    buffer_load_dwordx4 v56, s[48:51], s74 offen lds
    buffer_load_dwordx4 v56, s[52:55], s74 offen offset:1024 lds
    buffer_load_dwordx4 v57, s[48:51], s74 offen offset:2080 lds
    buffer_load_dwordx4 v57, s[52:55], s74 offen offset:3104 lds
    s_add_u32 s81, s80, 5
    s_and_b32 s81, s81, 15
    s_add_u32 m0, s88, 83200
    s_mul_i32 s74, s81, 114688
    buffer_load_dwordx4 v56, s[48:51], s74 offen lds
    buffer_load_dwordx4 v56, s[52:55], s74 offen offset:1024 lds
    buffer_load_dwordx4 v57, s[48:51], s74 offen offset:2080 lds
    buffer_load_dwordx4 v57, s[52:55], s74 offen offset:3104 lds
    s_cmp_lg_u32 s30, 0
    s_cbranch_scc1 L_nopoll2
    s_and_b32 s3, s2, 63
    s_mul_i32 s3, s3, 2048
    s_add_u32 s3, s3, 6553600
    s_add_u32 s20, s64, s3
    s_addc_u32 s21, s65, 0
    s_mov_b32 s22, 0x40000
L_poll_2:
    s_load_dword s12, s[20:21], 0 glc
    s_load_dword s13, s[20:21], 256 glc
    s_load_dword s14, s[20:21], 512 glc
    s_load_dword s15, s[20:21], 768 glc
    s_load_dword s16, s[20:21], 1024 glc
    s_load_dword s17, s[20:21], 1280 glc
    s_load_dword s18, s[20:21], 1536 glc
    s_load_dword s19, s[20:21], 1792 glc
    s_sub_u32 s22, s22, 1
    s_waitcnt lgkmcnt(0)
    s_cbranch_scc1 L_polled_2
    s_add_u32 s12, s12, s13
    s_add_u32 s12, s12, s14
    s_add_u32 s12, s12, s15
    s_add_u32 s12, s12, s16
    s_add_u32 s12, s12, s17
    s_add_u32 s12, s12, s18
    s_add_u32 s12, s12, s19
    s_cmp_lg_u32 s12, 256
    s_cbranch_scc1 L_poll_2
L_polled_2:
L_nopoll2:
    s_barrier
    s_add_u32 s81, s80, 0
    s_and_b32 s81, s81, 15
    s_add_u32 m0, s89, 0
    s_lshl_b32 s75, s81, 13
    buffer_load_dwordx4 v58, s[64:67], s75 offen sc1 lds
    buffer_load_dwordx4 v59, s[64:67], s75 offen offset:1056 sc1 lds
    s_add_u32 s81, s80, 1
    s_and_b32 s81, s81, 15
    s_add_u32 m0, s89, 8448
    s_lshl_b32 s75, s81, 13
    buffer_load_dwordx4 v58, s[64:67], s75 offen sc1 lds
    buffer_load_dwordx4 v59, s[64:67], s75 offen offset:1056 sc1 lds
    s_add_u32 s81, s80, 2
    s_and_b32 s81, s81, 15
    s_add_u32 m0, s89, 16896
    s_lshl_b32 s75, s81, 13
    buffer_load_dwordx4 v58, s[64:67], s75 offen sc1 lds
    buffer_load_dwordx4 v59, s[64:67], s75 offen offset:1056 sc1 lds
    s_add_u32 s81, s80, 3
    s_and_b32 s81, s81, 15
    s_add_u32 m0, s89, 25344
    s_lshl_b32 s75, s81, 13
    buffer_load_dwordx4 v58, s[64:67], s75 offen sc1 lds
    buffer_load_dwordx4 v59, s[64:67], s75 offen offset:1056 sc1 lds
    s_add_u32 s81, s80, 4
    s_and_b32 s81, s81, 15
    s_add_u32 m0, s89, 33792
    s_lshl_b32 s75, s81, 13
    buffer_load_dwordx4 v58, s[64:67], s75 offen sc1 lds
    buffer_load_dwordx4 v59, s[64:67], s75 offen offset:1056 sc1 lds
    s_add_u32 s81, s80, 5
    s_and_b32 s81, s81, 15
    s_add_u32 m0, s89, 42240
    s_lshl_b32 s75, s81, 13
    buffer_load_dwordx4 v58, s[64:67], s75 offen sc1 lds
    buffer_load_dwordx4 v59, s[64:67], s75 offen offset:1056 sc1 lds
    s_waitcnt vmcnt(10)
    s_barrier
    ds_read_b64_tr_b16 a[32:33], v14 offset:0
    ds_read_b64_tr_b16 a[34:35], v14 offset:512
    ds_read_b64_tr_b16 a[36:37], v15 offset:0
    ds_read_b64_tr_b16 a[38:39], v15 offset:512
    ds_read_b64_tr_b16 a[40:41], v16 offset:0
    ds_read_b64_tr_b16 a[42:43], v16 offset:512
    ds_read_b64_tr_b16 a[44:45], v17 offset:0
    ds_read_b64_tr_b16 a[46:47], v17 offset:512
    ds_read_b64_tr_b16 a[0:1], v8 offset:0
    ds_read_b64_tr_b16 a[2:3], v8 offset:512
    ds_read_b64_tr_b16 a[4:5], v8 offset:1024
    ds_read_b64_tr_b16 a[6:7], v8 offset:1536
    ds_read_b64_tr_b16 a[8:9], v8 offset:32
    ds_read_b64_tr_b16 a[10:11], v8 offset:544
    ds_read_b64_tr_b16 a[12:13], v8 offset:1056
    ds_read_b64_tr_b16 a[14:15], v8 offset:1568
    ds_read_b64_tr_b16 a[16:17], v8 offset:64
    ds_read_b64_tr_b16 a[18:19], v8 offset:576
    ds_read_b64_tr_b16 a[20:21], v8 offset:1088
    ds_read_b64_tr_b16 a[22:23], v8 offset:1600
    ds_read_b64_tr_b16 a[24:25], v11 offset:0
    ds_read_b64_tr_b16 a[26:27], v11 offset:512
    ds_read_b64_tr_b16 a[28:29], v11 offset:1024
    ds_read_b64_tr_b16 a[30:31], v11 offset:1536
    s_waitcnt vmcnt(8) lgkmcnt(0)
    s_barrier
    v_mfma_f32_16x16x32_bf16 v[240:243], a[252:255], a[32:35], 0
    ds_read_b64_tr_b16 a[80:81], v14 offset:8448
    v_mfma_f32_16x16x32_bf16 v[244:247], a[252:255], a[36:39], 0
    ds_read_b64_tr_b16 a[82:83], v14 offset:8960
    v_mfma_f32_16x16x32_bf16 v[248:251], a[32:35], a[32:35], 0
    ds_read_b64_tr_b16 a[84:85], v15 offset:8448
    v_mfma_f32_16x16x32_bf16 v[252:255], a[36:39], a[36:39], 0
    ds_read_b64_tr_b16 a[86:87], v15 offset:8960
    v_mfma_f32_16x16x32_bf16 v[128:131], a[0:3], a[32:35], 0
    ds_read_b64_tr_b16 a[88:89], v16 offset:8448
    v_mfma_f32_16x16x32_bf16 v[132:135], a[0:3], a[36:39], 0
    ds_read_b64_tr_b16 a[90:91], v16 offset:8960
    s_add_u32 s81, s80, 6
    s_and_b32 s81, s81, 15
    s_add_u32 m0, s88, 0
    s_mul_i32 s74, s81, 114688
    buffer_load_dwordx4 v56, s[48:51], s74 offen lds
    v_mfma_f32_16x16x32_bf16 v[136:139], a[0:3], a[40:43], 0
    v_mfma_f32_16x16x32_bf16 v[140:143], a[0:3], a[44:47], 0
    ds_read_b64_tr_b16 a[92:93], v17 offset:8448
    v_mfma_f32_16x16x32_bf16 v[144:147], a[4:7], a[32:35], 0
    ds_read_b64_tr_b16 a[94:95], v17 offset:8960
    v_mfma_f32_16x16x32_bf16 v[148:151], a[4:7], a[36:39], 0
    ds_read_b64_tr_b16 a[48:49], v8 offset:16640
    v_mfma_f32_16x16x32_bf16 v[152:155], a[4:7], a[40:43], 0
    ds_read_b64_tr_b16 a[50:51], v8 offset:17152
    buffer_load_dwordx4 v56, s[52:55], s74 offen offset:1024 lds
    v_mfma_f32_16x16x32_bf16 v[156:159], a[4:7], a[44:47], 0
    ds_read_b64_tr_b16 a[52:53], v8 offset:17664
    v_mfma_f32_16x16x32_bf16 v[160:163], a[8:11], a[32:35], 0
    ds_read_b64_tr_b16 a[54:55], v8 offset:18176
    v_mfma_f32_16x16x32_bf16 v[164:167], a[8:11], a[36:39], 0
    v_mfma_f32_16x16x32_bf16 v[168:171], a[8:11], a[40:43], 0
    ds_read_b64_tr_b16 a[56:57], v8 offset:16672
    v_mfma_f32_16x16x32_bf16 v[172:175], a[8:11], a[44:47], 0
    ds_read_b64_tr_b16 a[58:59], v8 offset:17184
    buffer_load_dwordx4 v57, s[48:51], s74 offen offset:2080 lds
    v_mfma_f32_16x16x32_bf16 v[176:179], a[12:15], a[32:35], 0
    ds_read_b64_tr_b16 a[60:61], v8 offset:17696
    v_mfma_f32_16x16x32_bf16 v[180:183], a[12:15], a[36:39], 0
    ds_read_b64_tr_b16 a[62:63], v8 offset:18208
    v_mfma_f32_16x16x32_bf16 v[184:187], a[12:15], a[40:43], 0
    ds_read_b64_tr_b16 a[64:65], v8 offset:16704
    v_mfma_f32_16x16x32_bf16 v[188:191], a[12:15], a[44:47], 0
    ds_read_b64_tr_b16 a[66:67], v8 offset:17216
    v_mfma_f32_16x16x32_bf16 v[192:195], a[16:19], a[32:35], 0
    v_mfma_f32_16x16x32_bf16 v[196:199], a[16:19], a[36:39], 0
    ds_read_b64_tr_b16 a[68:69], v8 offset:17728
    buffer_load_dwordx4 v57, s[52:55], s74 offen offset:3104 lds
    v_mfma_f32_16x16x32_bf16 v[200:203], a[16:19], a[40:43], 0
    ds_read_b64_tr_b16 a[70:71], v8 offset:18240
    v_mfma_f32_16x16x32_bf16 v[204:207], a[16:19], a[44:47], 0
    ds_read_b64_tr_b16 a[72:73], v11 offset:16640
    v_mfma_f32_16x16x32_bf16 v[208:211], a[20:23], a[32:35], 0
    ds_read_b64_tr_b16 a[74:75], v11 offset:17152
    v_mfma_f32_16x16x32_bf16 v[212:215], a[20:23], a[36:39], 0
    ds_read_b64_tr_b16 a[76:77], v11 offset:17664
    v_mfma_f32_16x16x32_bf16 v[216:219], a[20:23], a[40:43], 0
    ds_read_b64_tr_b16 a[78:79], v11 offset:18176
    s_add_u32 m0, s89, 0
    s_lshl_b32 s75, s81, 13
    buffer_load_dwordx4 v58, s[64:67], s75 offen sc1 lds
    v_mfma_f32_16x16x32_bf16 v[220:223], a[20:23], a[44:47], 0
    v_mfma_f32_16x16x32_bf16 v[224:227], a[24:27], a[32:35], 0
    v_mfma_f32_16x16x32_bf16 v[228:231], a[24:27], a[36:39], 0
    v_mfma_f32_16x16x32_bf16 v[232:235], a[28:31], a[32:35], 0
    v_mfma_f32_16x16x32_bf16 v[236:239], a[28:31], a[36:39], 0
    buffer_load_dwordx4 v59, s[64:67], s75 offen offset:1056 sc1 lds
    s_waitcnt vmcnt(12) lgkmcnt(0)
    s_barrier
    v_mfma_f32_16x16x32_bf16 v[128:131], a[48:51], a[80:83], v[128:131]
    ds_read_b64_tr_b16 a[32:33], v14 offset:16896
    v_mfma_f32_16x16x32_bf16 v[132:135], a[48:51], a[84:87], v[132:135]
    ds_read_b64_tr_b16 a[34:35], v14 offset:17408
    v_cndmask_b32 v241, v248, v249, s[4:5]
    v_mfma_f32_16x16x32_bf16 v[136:139], a[48:51], a[88:91], v[136:139]
    ds_read_b64_tr_b16 a[36:37], v15 offset:16896
    v_mfma_f32_16x16x32_bf16 v[140:143], a[48:51], a[92:95], v[140:143]
    ds_read_b64_tr_b16 a[38:39], v15 offset:17408
    v_cndmask_b32 v241, v241, v250, s[6:7]
    v_mfma_f32_16x16x32_bf16 v[144:147], a[52:55], a[80:83], v[144:147]
    ds_read_b64_tr_b16 a[40:41], v16 offset:16896
    v_mfma_f32_16x16x32_bf16 v[148:151], a[52:55], a[84:87], v[148:151]
    ds_read_b64_tr_b16 a[42:43], v16 offset:17408
    v_cndmask_b32 v241, v241, v251, s[8:9]
    v_mfma_f32_16x16x32_bf16 v[152:155], a[52:55], a[88:91], v[152:155]
    ds_read_b64_tr_b16 a[44:45], v17 offset:16896
    v_mfma_f32_16x16x32_bf16 v[156:159], a[52:55], a[92:95], v[156:159]
    ds_read_b64_tr_b16 a[46:47], v17 offset:17408
    v_cndmask_b32 v245, v252, v253, s[4:5]
    v_mfma_f32_16x16x32_bf16 v[160:163], a[56:59], a[80:83], v[160:163]
    ds_read_b64_tr_b16 a[0:1], v8 offset:33280
    v_mfma_f32_16x16x32_bf16 v[164:167], a[56:59], a[84:87], v[164:167]
    ds_read_b64_tr_b16 a[2:3], v8 offset:33792
    v_cndmask_b32 v245, v245, v254, s[6:7]
    v_mfma_f32_16x16x32_bf16 v[168:171], a[56:59], a[88:91], v[168:171]
    ds_read_b64_tr_b16 a[4:5], v8 offset:34304
    v_mfma_f32_16x16x32_bf16 v[172:175], a[56:59], a[92:95], v[172:175]
    ds_read_b64_tr_b16 a[6:7], v8 offset:34816
    v_cndmask_b32 v245, v245, v255, s[8:9]
    v_mfma_f32_16x16x32_bf16 v[176:179], a[60:63], a[80:83], v[176:179]
    ds_read_b64_tr_b16 a[8:9], v8 offset:33312
    v_mfma_f32_16x16x32_bf16 v[180:183], a[60:63], a[84:87], v[180:183]
    ds_read_b64_tr_b16 a[10:11], v8 offset:33824
    v_xor_b32 v1, 128, v18
    v_mfma_f32_16x16x32_bf16 v[184:187], a[60:63], a[88:91], v[184:187]
    ds_read_b64_tr_b16 a[12:13], v8 offset:34336
    v_mfma_f32_16x16x32_bf16 v[188:191], a[60:63], a[92:95], v[188:191]
    ds_read_b64_tr_b16 a[14:15], v8 offset:34848
    s_mov_b64 exec, s[10:11]
    buffer_store_dwordx2 v[240:241], v18, s[64:67], 0 offen sc1
    buffer_store_dwordx2 v[244:245], v1, s[64:67], 0 offen sc1
    s_mov_b64 exec, -1
    v_mfma_f32_16x16x32_bf16 v[192:195], a[64:67], a[80:83], v[192:195]
    ds_read_b64_tr_b16 a[16:17], v8 offset:33344
    v_mfma_f32_16x16x32_bf16 v[196:199], a[64:67], a[84:87], v[196:199]
    ds_read_b64_tr_b16 a[18:19], v8 offset:33856
    s_add_u32 s81, s80, 7
    s_and_b32 s81, s81, 15
    s_add_u32 m0, s88, 16640
    s_mul_i32 s74, s81, 114688
    buffer_load_dwordx4 v56, s[48:51], s74 offen lds
    v_mfma_f32_16x16x32_bf16 v[200:203], a[64:67], a[88:91], v[200:203]
    ds_read_b64_tr_b16 a[20:21], v8 offset:34368
    v_mfma_f32_16x16x32_bf16 v[204:207], a[64:67], a[92:95], v[204:207]
    ds_read_b64_tr_b16 a[22:23], v8 offset:34880
    buffer_load_dwordx4 v56, s[52:55], s74 offen offset:1024 lds
    v_mfma_f32_16x16x32_bf16 v[208:211], a[68:71], a[80:83], v[208:211]
    ds_read_b64_tr_b16 a[24:25], v11 offset:33280
    v_mfma_f32_16x16x32_bf16 v[212:215], a[68:71], a[84:87], v[212:215]
    ds_read_b64_tr_b16 a[26:27], v11 offset:33792
    buffer_load_dwordx4 v57, s[48:51], s74 offen offset:2080 lds
    v_mfma_f32_16x16x32_bf16 v[216:219], a[68:71], a[88:91], v[216:219]
    ds_read_b64_tr_b16 a[28:29], v11 offset:34304
    v_mfma_f32_16x16x32_bf16 v[220:223], a[68:71], a[92:95], v[220:223]
    ds_read_b64_tr_b16 a[30:31], v11 offset:34816
    buffer_load_dwordx4 v57, s[52:55], s74 offen offset:3104 lds
    v_mfma_f32_16x16x32_bf16 v[224:227], a[72:75], a[80:83], v[224:227]
    v_mfma_f32_16x16x32_bf16 v[228:231], a[72:75], a[84:87], v[228:231]
    s_add_u32 m0, s89, 8448
    s_lshl_b32 s75, s81, 13
    buffer_load_dwordx4 v58, s[64:67], s75 offen sc1 lds
    v_mfma_f32_16x16x32_bf16 v[232:235], a[76:79], a[80:83], v[232:235]
    v_mfma_f32_16x16x32_bf16 v[236:239], a[76:79], a[84:87], v[236:239]
    buffer_load_dwordx4 v59, s[64:67], s75 offen offset:1056 sc1 lds
    s_waitcnt vmcnt(18) lgkmcnt(0)
    s_barrier
    v_mfma_f32_16x16x32_bf16 v[128:131], a[0:3], a[32:35], v[128:131]
    ds_read_b64_tr_b16 a[80:81], v14 offset:25344
    v_mfma_f32_16x16x32_bf16 v[132:135], a[0:3], a[36:39], v[132:135]
    ds_read_b64_tr_b16 a[82:83], v14 offset:25856
    v_mfma_f32_16x16x32_bf16 v[136:139], a[0:3], a[40:43], v[136:139]
    ds_read_b64_tr_b16 a[84:85], v15 offset:25344
    s_mov_b32 s3, 0
    buffer_load_dword v4, v23, s[64:67], s3 offen sc1
    v_mfma_f32_16x16x32_bf16 v[140:143], a[0:3], a[44:47], v[140:143]
    ds_read_b64_tr_b16 a[86:87], v15 offset:25856
    v_mfma_f32_16x16x32_bf16 v[144:147], a[4:7], a[32:35], v[144:147]
    ds_read_b64_tr_b16 a[88:89], v16 offset:25344
    v_mfma_f32_16x16x32_bf16 v[148:151], a[4:7], a[36:39], v[148:151]
    ds_read_b64_tr_b16 a[90:91], v16 offset:25856
    s_mov_b32 s3, 14336
    buffer_load_dword v5, v23, s[64:67], s3 offen sc1
    v_mfma_f32_16x16x32_bf16 v[152:155], a[4:7], a[40:43], v[152:155]
    ds_read_b64_tr_b16 a[92:93], v17 offset:25344
    v_mfma_f32_16x16x32_bf16 v[156:159], a[4:7], a[44:47], v[156:159]
    ds_read_b64_tr_b16 a[94:95], v17 offset:25856
    v_mfma_f32_16x16x32_bf16 v[160:163], a[8:11], a[32:35], v[160:163]
    ds_read_b64_tr_b16 a[48:49], v9 offset:0
    s_mov_b32 s3, 28672
    buffer_load_dword v6, v23, s[64:67], s3 offen sc1
    v_mfma_f32_16x16x32_bf16 v[164:167], a[8:11], a[36:39], v[164:167]
    ds_read_b64_tr_b16 a[50:51], v9 offset:512
    v_mfma_f32_16x16x32_bf16 v[168:171], a[8:11], a[40:43], v[168:171]
    ds_read_b64_tr_b16 a[52:53], v9 offset:1024
    v_mfma_f32_16x16x32_bf16 v[172:175], a[8:11], a[44:47], v[172:175]
    ds_read_b64_tr_b16 a[54:55], v9 offset:1536
    s_mov_b32 s3, 43008
    buffer_load_dword v7, v23, s[64:67], s3 offen sc1
    v_mfma_f32_16x16x32_bf16 v[176:179], a[12:15], a[32:35], v[176:179]
    ds_read_b64_tr_b16 a[56:57], v9 offset:32
    v_mfma_f32_16x16x32_bf16 v[180:183], a[12:15], a[36:39], v[180:183]
    ds_read_b64_tr_b16 a[58:59], v9 offset:544
    s_add_u32 s81, s80, 8
    s_and_b32 s81, s81, 15
    s_add_u32 m0, s88, 33280
    s_mul_i32 s74, s81, 114688
    buffer_load_dwordx4 v56, s[48:51], s74 offen lds
    v_mfma_f32_16x16x32_bf16 v[184:187], a[12:15], a[40:43], v[184:187]
    ds_read_b64_tr_b16 a[60:61], v9 offset:1056
    v_mfma_f32_16x16x32_bf16 v[188:191], a[12:15], a[44:47], v[188:191]
    ds_read_b64_tr_b16 a[62:63], v9 offset:1568
    v_mfma_f32_16x16x32_bf16 v[192:195], a[16:19], a[32:35], v[192:195]
    ds_read_b64_tr_b16 a[64:65], v9 offset:64
    buffer_load_dwordx4 v56, s[52:55], s74 offen offset:1024 lds
    v_mfma_f32_16x16x32_bf16 v[196:199], a[16:19], a[36:39], v[196:199]
    ds_read_b64_tr_b16 a[66:67], v9 offset:576
    v_mfma_f32_16x16x32_bf16 v[200:203], a[16:19], a[40:43], v[200:203]
    ds_read_b64_tr_b16 a[68:69], v9 offset:1088
    v_mfma_f32_16x16x32_bf16 v[204:207], a[16:19], a[44:47], v[204:207]
    ds_read_b64_tr_b16 a[70:71], v9 offset:1600
    buffer_load_dwordx4 v57, s[48:51], s74 offen offset:2080 lds
    v_mfma_f32_16x16x32_bf16 v[208:211], a[20:23], a[32:35], v[208:211]
    ds_read_b64_tr_b16 a[72:73], v12 offset:0
    v_mfma_f32_16x16x32_bf16 v[212:215], a[20:23], a[36:39], v[212:215]
    ds_read_b64_tr_b16 a[74:75], v12 offset:512
    v_mfma_f32_16x16x32_bf16 v[216:219], a[20:23], a[40:43], v[216:219]
    ds_read_b64_tr_b16 a[76:77], v12 offset:1024
    buffer_load_dwordx4 v57, s[52:55], s74 offen offset:3104 lds
    v_mfma_f32_16x16x32_bf16 v[220:223], a[20:23], a[44:47], v[220:223]
    ds_read_b64_tr_b16 a[78:79], v12 offset:1536
    v_mfma_f32_16x16x32_bf16 v[224:227], a[24:27], a[32:35], v[224:227]
    v_mfma_f32_16x16x32_bf16 v[228:231], a[24:27], a[36:39], v[228:231]
    s_add_u32 m0, s89, 16896
    s_lshl_b32 s75, s81, 13
    buffer_load_dwordx4 v58, s[64:67], s75 offen sc1 lds
    v_mfma_f32_16x16x32_bf16 v[232:235], a[28:31], a[32:35], v[232:235]
    v_mfma_f32_16x16x32_bf16 v[236:239], a[28:31], a[36:39], v[236:239]
    buffer_load_dwordx4 v59, s[64:67], s75 offen offset:1056 sc1 lds
    s_waitcnt vmcnt(26) lgkmcnt(0)
    s_barrier
    v_mfma_f32_16x16x32_bf16 v[128:131], a[48:51], a[80:83], v[128:131]
    ds_read_b64_tr_b16 a[32:33], v14 offset:33792
    v_mfma_f32_16x16x32_bf16 v[132:135], a[48:51], a[84:87], v[132:135]
    ds_read_b64_tr_b16 a[34:35], v14 offset:34304
    v_mfma_f32_16x16x32_bf16 v[136:139], a[48:51], a[88:91], v[136:139]
    ds_read_b64_tr_b16 a[36:37], v15 offset:33792
    v_mfma_f32_16x16x32_bf16 v[140:143], a[48:51], a[92:95], v[140:143]
    ds_read_b64_tr_b16 a[38:39], v15 offset:34304
    v_mfma_f32_16x16x32_bf16 v[144:147], a[52:55], a[80:83], v[144:147]
    ds_read_b64_tr_b16 a[40:41], v16 offset:33792
    s_add_u32 s81, s80, 9
    s_and_b32 s81, s81, 15
    s_add_u32 m0, s88, 49920
    s_mul_i32 s74, s81, 114688
    buffer_load_dwordx4 v56, s[48:51], s74 offen lds
    v_mfma_f32_16x16x32_bf16 v[148:151], a[52:55], a[84:87], v[148:151]
    ds_read_b64_tr_b16 a[42:43], v16 offset:34304
    v_mfma_f32_16x16x32_bf16 v[152:155], a[52:55], a[88:91], v[152:155]
    ds_read_b64_tr_b16 a[44:45], v17 offset:33792
    v_mfma_f32_16x16x32_bf16 v[156:159], a[52:55], a[92:95], v[156:159]
    ds_read_b64_tr_b16 a[46:47], v17 offset:34304
    v_mfma_f32_16x16x32_bf16 v[160:163], a[56:59], a[80:83], v[160:163]
    ds_read_b64_tr_b16 a[0:1], v9 offset:16640
    v_mfma_f32_16x16x32_bf16 v[164:167], a[56:59], a[84:87], v[164:167]
    ds_read_b64_tr_b16 a[2:3], v9 offset:17152
    buffer_load_dwordx4 v56, s[52:55], s74 offen offset:1024 lds
    v_mfma_f32_16x16x32_bf16 v[168:171], a[56:59], a[88:91], v[168:171]
    ds_read_b64_tr_b16 a[4:5], v9 offset:17664
    v_mfma_f32_16x16x32_bf16 v[172:175], a[56:59], a[92:95], v[172:175]
    ds_read_b64_tr_b16 a[6:7], v9 offset:18176
    v_mfma_f32_16x16x32_bf16 v[176:179], a[60:63], a[80:83], v[176:179]
    ds_read_b64_tr_b16 a[8:9], v9 offset:16672
    v_mfma_f32_16x16x32_bf16 v[180:183], a[60:63], a[84:87], v[180:183]
    ds_read_b64_tr_b16 a[10:11], v9 offset:17184
    buffer_load_dwordx4 v57, s[48:51], s74 offen offset:2080 lds
    v_mfma_f32_16x16x32_bf16 v[184:187], a[60:63], a[88:91], v[184:187]
    ds_read_b64_tr_b16 a[12:13], v9 offset:17696
    v_mfma_f32_16x16x32_bf16 v[188:191], a[60:63], a[92:95], v[188:191]
    ds_read_b64_tr_b16 a[14:15], v9 offset:18208
    v_mfma_f32_16x16x32_bf16 v[192:195], a[64:67], a[80:83], v[192:195]
    ds_read_b64_tr_b16 a[16:17], v9 offset:16704
    v_mfma_f32_16x16x32_bf16 v[196:199], a[64:67], a[84:87], v[196:199]
    ds_read_b64_tr_b16 a[18:19], v9 offset:17216
    v_mfma_f32_16x16x32_bf16 v[200:203], a[64:67], a[88:91], v[200:203]
    ds_read_b64_tr_b16 a[20:21], v9 offset:17728
    buffer_load_dwordx4 v57, s[52:55], s74 offen offset:3104 lds
    v_mfma_f32_16x16x32_bf16 v[204:207], a[64:67], a[92:95], v[204:207]
    ds_read_b64_tr_b16 a[22:23], v9 offset:18240
    v_mfma_f32_16x16x32_bf16 v[208:211], a[68:71], a[80:83], v[208:211]
    ds_read_b64_tr_b16 a[24:25], v12 offset:16640
    v_mfma_f32_16x16x32_bf16 v[212:215], a[68:71], a[84:87], v[212:215]
    ds_read_b64_tr_b16 a[26:27], v12 offset:17152
    v_mfma_f32_16x16x32_bf16 v[216:219], a[68:71], a[88:91], v[216:219]
    ds_read_b64_tr_b16 a[28:29], v12 offset:17664
    v_mfma_f32_16x16x32_bf16 v[220:223], a[68:71], a[92:95], v[220:223]
    ds_read_b64_tr_b16 a[30:31], v12 offset:18176
    s_add_u32 m0, s89, 25344
    s_lshl_b32 s75, s81, 13
    buffer_load_dwordx4 v58, s[64:67], s75 offen sc1 lds
    v_mfma_f32_16x16x32_bf16 v[224:227], a[72:75], a[80:83], v[224:227]
    v_mfma_f32_16x16x32_bf16 v[228:231], a[72:75], a[84:87], v[228:231]
    v_mfma_f32_16x16x32_bf16 v[232:235], a[76:79], a[80:83], v[232:235]
    v_mfma_f32_16x16x32_bf16 v[236:239], a[76:79], a[84:87], v[236:239]
    buffer_load_dwordx4 v59, s[64:67], s75 offen offset:1056 sc1 lds
    s_waitcnt vmcnt(30) lgkmcnt(0)
    s_barrier
    v_mfma_f32_16x16x32_bf16 v[128:131], a[0:3], a[32:35], v[128:131]
    ds_read_b64_tr_b16 a[80:81], v14 offset:42240
    v_mfma_f32_16x16x32_bf16 v[132:135], a[0:3], a[36:39], v[132:135]
    ds_read_b64_tr_b16 a[82:83], v14 offset:42752
    v_mfma_f32_16x16x32_bf16 v[136:139], a[0:3], a[40:43], v[136:139]
    ds_read_b64_tr_b16 a[84:85], v15 offset:42240
    v_mfma_f32_16x16x32_bf16 v[140:143], a[0:3], a[44:47], v[140:143]
    ds_read_b64_tr_b16 a[86:87], v15 offset:42752
    v_mfma_f32_16x16x32_bf16 v[144:147], a[4:7], a[32:35], v[144:147]
    ds_read_b64_tr_b16 a[88:89], v16 offset:42240
    s_add_u32 s81, s80, 10
    s_and_b32 s81, s81, 15
    s_add_u32 m0, s88, 66560
    s_mul_i32 s74, s81, 114688
    buffer_load_dwordx4 v56, s[48:51], s74 offen lds
    v_mfma_f32_16x16x32_bf16 v[148:151], a[4:7], a[36:39], v[148:151]
    ds_read_b64_tr_b16 a[90:91], v16 offset:42752
    v_mfma_f32_16x16x32_bf16 v[152:155], a[4:7], a[40:43], v[152:155]
    ds_read_b64_tr_b16 a[92:93], v17 offset:42240
    v_mfma_f32_16x16x32_bf16 v[156:159], a[4:7], a[44:47], v[156:159]
    ds_read_b64_tr_b16 a[94:95], v17 offset:42752
    v_mfma_f32_16x16x32_bf16 v[160:163], a[8:11], a[32:35], v[160:163]
    ds_read_b64_tr_b16 a[48:49], v9 offset:33280
    v_mfma_f32_16x16x32_bf16 v[164:167], a[8:11], a[36:39], v[164:167]
    ds_read_b64_tr_b16 a[50:51], v9 offset:33792
    buffer_load_dwordx4 v56, s[52:55], s74 offen offset:1024 lds
    v_mfma_f32_16x16x32_bf16 v[168:171], a[8:11], a[40:43], v[168:171]
    ds_read_b64_tr_b16 a[52:53], v9 offset:34304
    v_mfma_f32_16x16x32_bf16 v[172:175], a[8:11], a[44:47], v[172:175]
    ds_read_b64_tr_b16 a[54:55], v9 offset:34816
    v_mfma_f32_16x16x32_bf16 v[176:179], a[12:15], a[32:35], v[176:179]
    ds_read_b64_tr_b16 a[56:57], v9 offset:33312
    v_mfma_f32_16x16x32_bf16 v[180:183], a[12:15], a[36:39], v[180:183]
    ds_read_b64_tr_b16 a[58:59], v9 offset:33824
    buffer_load_dwordx4 v57, s[48:51], s74 offen offset:2080 lds
    v_mfma_f32_16x16x32_bf16 v[184:187], a[12:15], a[40:43], v[184:187]
    ds_read_b64_tr_b16 a[60:61], v9 offset:34336
    v_mfma_f32_16x16x32_bf16 v[188:191], a[12:15], a[44:47], v[188:191]
    ds_read_b64_tr_b16 a[62:63], v9 offset:34848
    v_mfma_f32_16x16x32_bf16 v[192:195], a[16:19], a[32:35], v[192:195]
    ds_read_b64_tr_b16 a[64:65], v9 offset:33344
    v_mfma_f32_16x16x32_bf16 v[196:199], a[16:19], a[36:39], v[196:199]
    ds_read_b64_tr_b16 a[66:67], v9 offset:33856
    v_mfma_f32_16x16x32_bf16 v[200:203], a[16:19], a[40:43], v[200:203]
    ds_read_b64_tr_b16 a[68:69], v9 offset:34368
    buffer_load_dwordx4 v57, s[52:55], s74 offen offset:3104 lds
    v_mfma_f32_16x16x32_bf16 v[204:207], a[16:19], a[44:47], v[204:207]
    ds_read_b64_tr_b16 a[70:71], v9 offset:34880
    v_mfma_f32_16x16x32_bf16 v[208:211], a[20:23], a[32:35], v[208:211]
    ds_read_b64_tr_b16 a[72:73], v12 offset:33280
    v_mfma_f32_16x16x32_bf16 v[212:215], a[20:23], a[36:39], v[212:215]
    ds_read_b64_tr_b16 a[74:75], v12 offset:33792
    v_mfma_f32_16x16x32_bf16 v[216:219], a[20:23], a[40:43], v[216:219]
    ds_read_b64_tr_b16 a[76:77], v12 offset:34304
    v_mfma_f32_16x16x32_bf16 v[220:223], a[20:23], a[44:47], v[220:223]
    ds_read_b64_tr_b16 a[78:79], v12 offset:34816
    s_add_u32 m0, s89, 33792
    s_lshl_b32 s75, s81, 13
    buffer_load_dwordx4 v58, s[64:67], s75 offen sc1 lds
    v_mfma_f32_16x16x32_bf16 v[224:227], a[24:27], a[32:35], v[224:227]
    v_mfma_f32_16x16x32_bf16 v[228:231], a[24:27], a[36:39], v[228:231]
    v_mfma_f32_16x16x32_bf16 v[232:235], a[28:31], a[32:35], v[232:235]
    v_mfma_f32_16x16x32_bf16 v[236:239], a[28:31], a[36:39], v[236:239]
    buffer_load_dwordx4 v59, s[64:67], s75 offen offset:1056 sc1 lds
    s_waitcnt vmcnt(30) lgkmcnt(0)
    s_barrier
    v_mfma_f32_16x16x32_bf16 v[128:131], a[48:51], a[80:83], v[128:131]
    ds_read_b64_tr_b16 a[32:33], v14 offset:0
    v_mfma_f32_16x16x32_bf16 v[132:135], a[48:51], a[84:87], v[132:135]
    ds_read_b64_tr_b16 a[34:35], v14 offset:512
    v_mfma_f32_16x16x32_bf16 v[136:139], a[48:51], a[88:91], v[136:139]
    ds_read_b64_tr_b16 a[36:37], v15 offset:0
    v_lshrrev_b32 v3, 3, v0
    v_mfma_f32_16x16x32_bf16 v[140:143], a[48:51], a[92:95], v[140:143]
    ds_read_b64_tr_b16 a[38:39], v15 offset:512
    v_mfma_f32_16x16x32_bf16 v[144:147], a[52:55], a[80:83], v[144:147]
    ds_read_b64_tr_b16 a[40:41], v16 offset:0
    v_mfma_f32_16x16x32_bf16 v[148:151], a[52:55], a[84:87], v[148:151]
    ds_read_b64_tr_b16 a[42:43], v16 offset:512
    v_mul_u32_u24 v3, 768, v3
    v_mfma_f32_16x16x32_bf16 v[152:155], a[52:55], a[88:91], v[152:155]
    ds_read_b64_tr_b16 a[44:45], v17 offset:0
    v_mfma_f32_16x16x32_bf16 v[156:159], a[52:55], a[92:95], v[156:159]
    ds_read_b64_tr_b16 a[46:47], v17 offset:512
    v_sub_u32 v3, v62, v3
    v_mfma_f32_16x16x32_bf16 v[160:163], a[56:59], a[80:83], v[160:163]
    ds_read_b64_tr_b16 a[0:1], v8 offset:0
    v_mfma_f32_16x16x32_bf16 v[164:167], a[56:59], a[84:87], v[164:167]
    ds_read_b64_tr_b16 a[2:3], v8 offset:512
    v_mfma_f32_16x16x32_bf16 v[168:171], a[56:59], a[88:91], v[168:171]
    ds_read_b64_tr_b16 a[4:5], v8 offset:1024
    s_lshl_b32 s3, s85, 2
    s_add_u32 s3, s3, s30
    s_lshl_b32 s3, s3, 12
    s_lshr_b32 s23, s84, 1
    s_lshl_b32 s23, s23, 17
    s_add_u32 s23, s23, s3
    s_and_b32 s3, s84, 1
    s_lshl_b32 s3, s3, 7
    s_add_u32 s23, s23, s3
    s_add_u32 s23, s23, 4194304
    s_lshl_b32 s3, s30, 11
    s_add_u32 m0, s3, 153728
    s_nop 0
    buffer_load_dwordx4 v3, s[64:67], s23 offen sc1 lds
    v_mfma_f32_16x16x32_bf16 v[172:175], a[56:59], a[92:95], v[172:175]
    ds_read_b64_tr_b16 a[6:7], v8 offset:1536
    v_mfma_f32_16x16x32_bf16 v[176:179], a[60:63], a[80:83], v[176:179]
    ds_read_b64_tr_b16 a[8:9], v8 offset:32
    s_add_u32 s23, s23, 1024
    buffer_load_dwordx4 v3, s[64:67], s23 offen offset:1024 sc1 lds
    v_mfma_f32_16x16x32_bf16 v[180:183], a[60:63], a[84:87], v[180:183]
    ds_read_b64_tr_b16 a[10:11], v8 offset:544
    v_mfma_f32_16x16x32_bf16 v[184:187], a[60:63], a[88:91], v[184:187]
    ds_read_b64_tr_b16 a[12:13], v8 offset:1056
    v_mfma_f32_16x16x32_bf16 v[188:191], a[60:63], a[92:95], v[188:191]
    ds_read_b64_tr_b16 a[14:15], v8 offset:1568
    s_add_u32 s81, s80, 11
    s_and_b32 s81, s81, 15
    s_add_u32 m0, s88, 83200
    s_mul_i32 s74, s81, 114688
    buffer_load_dwordx4 v56, s[48:51], s74 offen lds
    v_mfma_f32_16x16x32_bf16 v[192:195], a[64:67], a[80:83], v[192:195]
    ds_read_b64_tr_b16 a[16:17], v8 offset:64
    v_mfma_f32_16x16x32_bf16 v[196:199], a[64:67], a[84:87], v[196:199]
    ds_read_b64_tr_b16 a[18:19], v8 offset:576
    buffer_load_dwordx4 v56, s[52:55], s74 offen offset:1024 lds
    v_mfma_f32_16x16x32_bf16 v[200:203], a[64:67], a[88:91], v[200:203]
    ds_read_b64_tr_b16 a[20:21], v8 offset:1088
    v_mfma_f32_16x16x32_bf16 v[204:207], a[64:67], a[92:95], v[204:207]
    ds_read_b64_tr_b16 a[22:23], v8 offset:1600
    v_mfma_f32_16x16x32_bf16 v[208:211], a[68:71], a[80:83], v[208:211]
    ds_read_b64_tr_b16 a[24:25], v11 offset:0
    buffer_load_dwordx4 v57, s[48:51], s74 offen offset:2080 lds
    v_mfma_f32_16x16x32_bf16 v[212:215], a[68:71], a[84:87], v[212:215]
    ds_read_b64_tr_b16 a[26:27], v11 offset:512
    v_mfma_f32_16x16x32_bf16 v[216:219], a[68:71], a[88:91], v[216:219]
    ds_read_b64_tr_b16 a[28:29], v11 offset:1024
    buffer_load_dwordx4 v57, s[52:55], s74 offen offset:3104 lds
    v_mfma_f32_16x16x32_bf16 v[220:223], a[68:71], a[92:95], v[220:223]
    ds_read_b64_tr_b16 a[30:31], v11 offset:1536
    v_mfma_f32_16x16x32_bf16 v[224:227], a[72:75], a[80:83], v[224:227]
    v_mfma_f32_16x16x32_bf16 v[228:231], a[72:75], a[84:87], v[228:231]
    s_add_u32 m0, s89, 42240
    s_lshl_b32 s75, s81, 13
    buffer_load_dwordx4 v58, s[64:67], s75 offen sc1 lds
    v_mfma_f32_16x16x32_bf16 v[232:235], a[76:79], a[80:83], v[232:235]
    v_mfma_f32_16x16x32_bf16 v[236:239], a[76:79], a[84:87], v[236:239]
    buffer_load_dwordx4 v59, s[64:67], s75 offen offset:1056 sc1 lds
    s_waitcnt vmcnt(30) lgkmcnt(0)
    s_barrier
    v_mfma_f32_16x16x32_bf16 v[128:131], a[0:3], a[32:35], v[128:131]
    ds_read_b64_tr_b16 a[80:81], v14 offset:8448
    v_mfma_f32_16x16x32_bf16 v[132:135], a[0:3], a[36:39], v[132:135]
    ds_read_b64_tr_b16 a[82:83], v14 offset:8960
    v_mfma_f32_16x16x32_bf16 v[136:139], a[0:3], a[40:43], v[136:139]
    ds_read_b64_tr_b16 a[84:85], v15 offset:8448
    v_mfma_f32_16x16x32_bf16 v[140:143], a[0:3], a[44:47], v[140:143]
    ds_read_b64_tr_b16 a[86:87], v15 offset:8960
    v_mov_b32 v2, 1
    v_mfma_f32_16x16x32_bf16 v[144:147], a[4:7], a[32:35], v[144:147]
    ds_read_b64_tr_b16 a[88:89], v16 offset:8448
    v_mfma_f32_16x16x32_bf16 v[148:151], a[4:7], a[36:39], v[148:151]
    ds_read_b64_tr_b16 a[90:91], v16 offset:8960
    v_mfma_f32_16x16x32_bf16 v[152:155], a[4:7], a[40:43], v[152:155]
    ds_read_b64_tr_b16 a[92:93], v17 offset:8448
    v_lshlrev_b32 v1, 10, v0
    v_mfma_f32_16x16x32_bf16 v[156:159], a[4:7], a[44:47], v[156:159]
    ds_read_b64_tr_b16 a[94:95], v17 offset:8960
    v_mfma_f32_16x16x32_bf16 v[160:163], a[8:11], a[32:35], v[160:163]
    ds_read_b64_tr_b16 a[48:49], v8 offset:16640
    v_mfma_f32_16x16x32_bf16 v[164:167], a[8:11], a[36:39], v[164:167]
    ds_read_b64_tr_b16 a[50:51], v8 offset:17152
    s_lshl_b32 s3, s90, 6
    s_add_u32 s3, s3, s30
    s_lshl_b32 s3, s3, 8
    s_add_u32 s3, s3, 6946816
    s_mov_b64 exec, 0xffff
    buffer_atomic_add v2, v1, s[64:67], s3 offen sc1
    s_mov_b64 exec, -1
    s_lshl_b32 s23, s91, 10
    s_add_u32 s3, s3, s23
    s_add_u32 s20, s64, s3
    s_addc_u32 s21, s65, 0
    v_mfma_f32_16x16x32_bf16 v[168:171], a[8:11], a[40:43], v[168:171]
    ds_read_b64_tr_b16 a[52:53], v8 offset:17664
    v_mfma_f32_16x16x32_bf16 v[172:175], a[8:11], a[44:47], v[172:175]
    ds_read_b64_tr_b16 a[54:55], v8 offset:18176
    v_mfma_f32_16x16x32_bf16 v[176:179], a[12:15], a[32:35], v[176:179]
    ds_read_b64_tr_b16 a[56:57], v8 offset:16672
    s_add_u32 s81, s80, 12
    s_and_b32 s81, s81, 15
    s_add_u32 m0, s88, 0
    s_mul_i32 s74, s81, 114688
    buffer_load_dwordx4 v56, s[48:51], s74 offen lds
    v_mfma_f32_16x16x32_bf16 v[180:183], a[12:15], a[36:39], v[180:183]
    ds_read_b64_tr_b16 a[58:59], v8 offset:17184
    v_mfma_f32_16x16x32_bf16 v[184:187], a[12:15], a[40:43], v[184:187]
    ds_read_b64_tr_b16 a[60:61], v8 offset:17696
    v_mfma_f32_16x16x32_bf16 v[188:191], a[12:15], a[44:47], v[188:191]
    ds_read_b64_tr_b16 a[62:63], v8 offset:18208
    buffer_load_dwordx4 v56, s[52:55], s74 offen offset:1024 lds
    v_mfma_f32_16x16x32_bf16 v[192:195], a[16:19], a[32:35], v[192:195]
    ds_read_b64_tr_b16 a[64:65], v8 offset:16704
    v_mfma_f32_16x16x32_bf16 v[196:199], a[16:19], a[36:39], v[196:199]
    ds_read_b64_tr_b16 a[66:67], v8 offset:17216
    v_mfma_f32_16x16x32_bf16 v[200:203], a[16:19], a[40:43], v[200:203]
    ds_read_b64_tr_b16 a[68:69], v8 offset:17728
    buffer_load_dwordx4 v57, s[48:51], s74 offen offset:2080 lds
    v_mfma_f32_16x16x32_bf16 v[204:207], a[16:19], a[44:47], v[204:207]
    ds_read_b64_tr_b16 a[70:71], v8 offset:18240
    v_mfma_f32_16x16x32_bf16 v[208:211], a[20:23], a[32:35], v[208:211]
    ds_read_b64_tr_b16 a[72:73], v11 offset:16640
    v_mfma_f32_16x16x32_bf16 v[212:215], a[20:23], a[36:39], v[212:215]
    ds_read_b64_tr_b16 a[74:75], v11 offset:17152
    buffer_load_dwordx4 v57, s[52:55], s74 offen offset:3104 lds
    v_mfma_f32_16x16x32_bf16 v[216:219], a[20:23], a[40:43], v[216:219]
    ds_read_b64_tr_b16 a[76:77], v11 offset:17664
    v_mfma_f32_16x16x32_bf16 v[220:223], a[20:23], a[44:47], v[220:223]
    ds_read_b64_tr_b16 a[78:79], v11 offset:18176
    v_mfma_f32_16x16x32_bf16 v[224:227], a[24:27], a[32:35], v[224:227]
    s_add_u32 m0, s89, 0
    s_lshl_b32 s75, s81, 13
    buffer_load_dwordx4 v58, s[64:67], s75 offen sc1 lds
    v_mfma_f32_16x16x32_bf16 v[228:231], a[24:27], a[36:39], v[228:231]
    v_mfma_f32_16x16x32_bf16 v[232:235], a[28:31], a[32:35], v[232:235]
    v_mfma_f32_16x16x32_bf16 v[236:239], a[28:31], a[36:39], v[236:239]
    buffer_load_dwordx4 v59, s[64:67], s75 offen offset:1056 sc1 lds
    s_waitcnt vmcnt(27) lgkmcnt(0)
    s_barrier
    v_mfma_f32_16x16x32_bf16 v[128:131], a[48:51], a[80:83], v[128:131]
    ds_read_b64_tr_b16 a[32:33], v14 offset:16896
    v_mfma_f32_16x16x32_bf16 v[132:135], a[48:51], a[84:87], v[132:135]
    ds_read_b64_tr_b16 a[34:35], v14 offset:17408
    v_mfma_f32_16x16x32_bf16 v[136:139], a[48:51], a[88:91], v[136:139]
    ds_read_b64_tr_b16 a[36:37], v15 offset:16896
    v_mfma_f32_16x16x32_bf16 v[140:143], a[48:51], a[92:95], v[140:143]
    ds_read_b64_tr_b16 a[38:39], v15 offset:17408
    v_mfma_f32_16x16x32_bf16 v[144:147], a[52:55], a[80:83], v[144:147]
    ds_read_b64_tr_b16 a[40:41], v16 offset:16896
    s_add_u32 s81, s80, 13
    s_and_b32 s81, s81, 15
    s_add_u32 m0, s88, 16640
    s_mul_i32 s74, s81, 114688
    buffer_load_dwordx4 v56, s[48:51], s74 offen lds
    v_mfma_f32_16x16x32_bf16 v[148:151], a[52:55], a[84:87], v[148:151]
    ds_read_b64_tr_b16 a[42:43], v16 offset:17408
    v_mfma_f32_16x16x32_bf16 v[152:155], a[52:55], a[88:91], v[152:155]
    ds_read_b64_tr_b16 a[44:45], v17 offset:16896
    v_mfma_f32_16x16x32_bf16 v[156:159], a[52:55], a[92:95], v[156:159]
    ds_read_b64_tr_b16 a[46:47], v17 offset:17408
    v_mfma_f32_16x16x32_bf16 v[160:163], a[56:59], a[80:83], v[160:163]
    ds_read_b64_tr_b16 a[0:1], v8 offset:33280
    v_mfma_f32_16x16x32_bf16 v[164:167], a[56:59], a[84:87], v[164:167]
    ds_read_b64_tr_b16 a[2:3], v8 offset:33792
    buffer_load_dwordx4 v56, s[52:55], s74 offen offset:1024 lds
    v_mfma_f32_16x16x32_bf16 v[168:171], a[56:59], a[88:91], v[168:171]
    ds_read_b64_tr_b16 a[4:5], v8 offset:34304
    v_mfma_f32_16x16x32_bf16 v[172:175], a[56:59], a[92:95], v[172:175]
    ds_read_b64_tr_b16 a[6:7], v8 offset:34816
    v_mfma_f32_16x16x32_bf16 v[176:179], a[60:63], a[80:83], v[176:179]
    ds_read_b64_tr_b16 a[8:9], v8 offset:33312
    v_mfma_f32_16x16x32_bf16 v[180:183], a[60:63], a[84:87], v[180:183]
    ds_read_b64_tr_b16 a[10:11], v8 offset:33824
    buffer_load_dwordx4 v57, s[48:51], s74 offen offset:2080 lds
    v_mfma_f32_16x16x32_bf16 v[184:187], a[60:63], a[88:91], v[184:187]
    ds_read_b64_tr_b16 a[12:13], v8 offset:34336
    v_mfma_f32_16x16x32_bf16 v[188:191], a[60:63], a[92:95], v[188:191]
    ds_read_b64_tr_b16 a[14:15], v8 offset:34848
    v_mfma_f32_16x16x32_bf16 v[192:195], a[64:67], a[80:83], v[192:195]
    ds_read_b64_tr_b16 a[16:17], v8 offset:33344
    v_mfma_f32_16x16x32_bf16 v[196:199], a[64:67], a[84:87], v[196:199]
    ds_read_b64_tr_b16 a[18:19], v8 offset:33856
    v_mfma_f32_16x16x32_bf16 v[200:203], a[64:67], a[88:91], v[200:203]
    ds_read_b64_tr_b16 a[20:21], v8 offset:34368
    buffer_load_dwordx4 v57, s[52:55], s74 offen offset:3104 lds
    v_mfma_f32_16x16x32_bf16 v[204:207], a[64:67], a[92:95], v[204:207]
    ds_read_b64_tr_b16 a[22:23], v8 offset:34880
    v_mfma_f32_16x16x32_bf16 v[208:211], a[68:71], a[80:83], v[208:211]
    ds_read_b64_tr_b16 a[24:25], v11 offset:33280
    v_mfma_f32_16x16x32_bf16 v[212:215], a[68:71], a[84:87], v[212:215]
    ds_read_b64_tr_b16 a[26:27], v11 offset:33792
    v_mfma_f32_16x16x32_bf16 v[216:219], a[68:71], a[88:91], v[216:219]
    ds_read_b64_tr_b16 a[28:29], v11 offset:34304
    v_mfma_f32_16x16x32_bf16 v[220:223], a[68:71], a[92:95], v[220:223]
    ds_read_b64_tr_b16 a[30:31], v11 offset:34816
    s_add_u32 m0, s89, 8448
    s_lshl_b32 s75, s81, 13
    buffer_load_dwordx4 v58, s[64:67], s75 offen sc1 lds
    v_mfma_f32_16x16x32_bf16 v[224:227], a[72:75], a[80:83], v[224:227]
    v_mfma_f32_16x16x32_bf16 v[228:231], a[72:75], a[84:87], v[228:231]
    v_mfma_f32_16x16x32_bf16 v[232:235], a[76:79], a[80:83], v[232:235]
    v_mfma_f32_16x16x32_bf16 v[236:239], a[76:79], a[84:87], v[236:239]
    buffer_load_dwordx4 v59, s[64:67], s75 offen offset:1056 sc1 lds
    s_waitcnt vmcnt(27) lgkmcnt(0)
    s_barrier
    v_mfma_f32_16x16x32_bf16 v[128:131], a[0:3], a[32:35], v[128:131]
    ds_read_b64_tr_b16 a[80:81], v14 offset:25344
    v_mfma_f32_16x16x32_bf16 v[132:135], a[0:3], a[36:39], v[132:135]
    ds_read_b64_tr_b16 a[82:83], v14 offset:25856
    v_mfma_f32_16x16x32_bf16 v[136:139], a[0:3], a[40:43], v[136:139]
    ds_read_b64_tr_b16 a[84:85], v15 offset:25344
    v_add_f32 v4, v4, v5
    v_mfma_f32_16x16x32_bf16 v[140:143], a[0:3], a[44:47], v[140:143]
    ds_read_b64_tr_b16 a[86:87], v15 offset:25856
    v_mfma_f32_16x16x32_bf16 v[144:147], a[4:7], a[32:35], v[144:147]
    ds_read_b64_tr_b16 a[88:89], v16 offset:25344
    v_mfma_f32_16x16x32_bf16 v[148:151], a[4:7], a[36:39], v[148:151]
    ds_read_b64_tr_b16 a[90:91], v16 offset:25856
    v_add_f32 v6, v6, v7
    v_mfma_f32_16x16x32_bf16 v[152:155], a[4:7], a[40:43], v[152:155]
    ds_read_b64_tr_b16 a[92:93], v17 offset:25344
    v_mfma_f32_16x16x32_bf16 v[156:159], a[4:7], a[44:47], v[156:159]
    ds_read_b64_tr_b16 a[94:95], v17 offset:25856
    v_mfma_f32_16x16x32_bf16 v[160:163], a[8:11], a[32:35], v[160:163]
    ds_read_b64_tr_b16 a[48:49], v9 offset:0
    v_add_f32 v4, v4, v6
    v_mfma_f32_16x16x32_bf16 v[164:167], a[8:11], a[36:39], v[164:167]
    ds_read_b64_tr_b16 a[50:51], v9 offset:512
    v_mfma_f32_16x16x32_bf16 v[168:171], a[8:11], a[40:43], v[168:171]
    ds_read_b64_tr_b16 a[52:53], v9 offset:1024
    v_mfma_f32_16x16x32_bf16 v[172:175], a[8:11], a[44:47], v[172:175]
    ds_read_b64_tr_b16 a[54:55], v9 offset:1536
    ds_write_b32 v13, v4
    v_mfma_f32_16x16x32_bf16 v[176:179], a[12:15], a[32:35], v[176:179]
    ds_read_b64_tr_b16 a[56:57], v9 offset:32
    v_mfma_f32_16x16x32_bf16 v[180:183], a[12:15], a[36:39], v[180:183]
    ds_read_b64_tr_b16 a[58:59], v9 offset:544
    s_add_u32 s81, s80, 14
    s_and_b32 s81, s81, 15
    s_add_u32 m0, s88, 33280
    s_mul_i32 s74, s81, 114688
    buffer_load_dwordx4 v56, s[48:51], s74 offen lds
    v_mfma_f32_16x16x32_bf16 v[184:187], a[12:15], a[40:43], v[184:187]
    ds_read_b64_tr_b16 a[60:61], v9 offset:1056
    v_mfma_f32_16x16x32_bf16 v[188:191], a[12:15], a[44:47], v[188:191]
    ds_read_b64_tr_b16 a[62:63], v9 offset:1568
    v_mfma_f32_16x16x32_bf16 v[192:195], a[16:19], a[32:35], v[192:195]
    ds_read_b64_tr_b16 a[64:65], v9 offset:64
    buffer_load_dwordx4 v56, s[52:55], s74 offen offset:1024 lds
    v_mfma_f32_16x16x32_bf16 v[196:199], a[16:19], a[36:39], v[196:199]
    ds_read_b64_tr_b16 a[66:67], v9 offset:576
    v_mfma_f32_16x16x32_bf16 v[200:203], a[16:19], a[40:43], v[200:203]
    ds_read_b64_tr_b16 a[68:69], v9 offset:1088
    v_mfma_f32_16x16x32_bf16 v[204:207], a[16:19], a[44:47], v[204:207]
    ds_read_b64_tr_b16 a[70:71], v9 offset:1600
    buffer_load_dwordx4 v57, s[48:51], s74 offen offset:2080 lds
    v_mfma_f32_16x16x32_bf16 v[208:211], a[20:23], a[32:35], v[208:211]
    ds_read_b64_tr_b16 a[72:73], v12 offset:0
    v_mfma_f32_16x16x32_bf16 v[212:215], a[20:23], a[36:39], v[212:215]
    ds_read_b64_tr_b16 a[74:75], v12 offset:512
    v_mfma_f32_16x16x32_bf16 v[216:219], a[20:23], a[40:43], v[216:219]
    ds_read_b64_tr_b16 a[76:77], v12 offset:1024
    buffer_load_dwordx4 v57, s[52:55], s74 offen offset:3104 lds
    v_mfma_f32_16x16x32_bf16 v[220:223], a[20:23], a[44:47], v[220:223]
    ds_read_b64_tr_b16 a[78:79], v12 offset:1536
    v_mfma_f32_16x16x32_bf16 v[224:227], a[24:27], a[32:35], v[224:227]
    v_mfma_f32_16x16x32_bf16 v[228:231], a[24:27], a[36:39], v[228:231]
    s_add_u32 m0, s89, 16896
    s_lshl_b32 s75, s81, 13
    buffer_load_dwordx4 v58, s[64:67], s75 offen sc1 lds
    v_mfma_f32_16x16x32_bf16 v[232:235], a[28:31], a[32:35], v[232:235]
    v_mfma_f32_16x16x32_bf16 v[236:239], a[28:31], a[36:39], v[236:239]
    buffer_load_dwordx4 v59, s[64:67], s75 offen offset:1056 sc1 lds
    s_waitcnt vmcnt(27) lgkmcnt(0)
    s_barrier
    v_mfma_f32_16x16x32_bf16 v[128:131], a[48:51], a[80:83], v[128:131]
    ds_read_b64_tr_b16 a[32:33], v14 offset:33792
    v_mfma_f32_16x16x32_bf16 v[132:135], a[48:51], a[84:87], v[132:135]
    ds_read_b64_tr_b16 a[34:35], v14 offset:34304
    v_mfma_f32_16x16x32_bf16 v[136:139], a[48:51], a[88:91], v[136:139]
    ds_read_b64_tr_b16 a[36:37], v15 offset:33792
    v_mfma_f32_16x16x32_bf16 v[140:143], a[48:51], a[92:95], v[140:143]
    ds_read_b64_tr_b16 a[38:39], v15 offset:34304
    s_load_dword s12, s[20:21], 0 glc
    v_mfma_f32_16x16x32_bf16 v[144:147], a[52:55], a[80:83], v[144:147]
    ds_read_b64_tr_b16 a[40:41], v16 offset:33792
    v_mfma_f32_16x16x32_bf16 v[148:151], a[52:55], a[84:87], v[148:151]
    ds_read_b64_tr_b16 a[42:43], v16 offset:34304
    v_mfma_f32_16x16x32_bf16 v[152:155], a[52:55], a[88:91], v[152:155]
    ds_read_b64_tr_b16 a[44:45], v17 offset:33792
    v_xor_b32 v1, 128, v19
    v_mfma_f32_16x16x32_bf16 v[156:159], a[52:55], a[92:95], v[156:159]
    ds_read_b64_tr_b16 a[46:47], v17 offset:34304
    v_mfma_f32_16x16x32_bf16 v[160:163], a[56:59], a[80:83], v[160:163]
    ds_read_b64_tr_b16 a[0:1], v9 offset:16640
    v_mfma_f32_16x16x32_bf16 v[164:167], a[56:59], a[84:87], v[164:167]
    ds_read_b64_tr_b16 a[2:3], v9 offset:17152
    s_mov_b32 s23, 8192
    v_mfma_f32_16x16x32_bf16 v[168:171], a[56:59], a[88:91], v[168:171]
    ds_read_b64_tr_b16 a[4:5], v9 offset:17664
    v_mfma_f32_16x16x32_bf16 v[172:175], a[56:59], a[92:95], v[172:175]
    ds_read_b64_tr_b16 a[6:7], v9 offset:18176
    v_mfma_f32_16x16x32_bf16 v[176:179], a[60:63], a[80:83], v[176:179]
    ds_read_b64_tr_b16 a[8:9], v9 offset:16672
    s_add_u32 s81, s80, 15
    s_and_b32 s81, s81, 15
    s_add_u32 m0, s88, 49920
    s_mul_i32 s74, s81, 114688
    buffer_load_dwordx4 v56, s[48:51], s74 offen lds
    v_mfma_f32_16x16x32_bf16 v[180:183], a[60:63], a[84:87], v[180:183]
    ds_read_b64_tr_b16 a[10:11], v9 offset:17184
    v_mfma_f32_16x16x32_bf16 v[184:187], a[60:63], a[88:91], v[184:187]
    ds_read_b64_tr_b16 a[12:13], v9 offset:17696
    v_mfma_f32_16x16x32_bf16 v[188:191], a[60:63], a[92:95], v[188:191]
    ds_read_b64_tr_b16 a[14:15], v9 offset:18208
    buffer_load_dwordx4 v56, s[52:55], s74 offen offset:1024 lds
    v_mfma_f32_16x16x32_bf16 v[192:195], a[64:67], a[80:83], v[192:195]
    ds_read_b64_tr_b16 a[16:17], v9 offset:16704
    v_mfma_f32_16x16x32_bf16 v[196:199], a[64:67], a[84:87], v[196:199]
    ds_read_b64_tr_b16 a[18:19], v9 offset:17216
    v_mfma_f32_16x16x32_bf16 v[200:203], a[64:67], a[88:91], v[200:203]
    ds_read_b64_tr_b16 a[20:21], v9 offset:17728
    buffer_load_dwordx4 v57, s[48:51], s74 offen offset:2080 lds
    v_mfma_f32_16x16x32_bf16 v[204:207], a[64:67], a[92:95], v[204:207]
    ds_read_b64_tr_b16 a[22:23], v9 offset:18240
    v_mfma_f32_16x16x32_bf16 v[208:211], a[68:71], a[80:83], v[208:211]
    ds_read_b64_tr_b16 a[24:25], v12 offset:16640
    v_mfma_f32_16x16x32_bf16 v[212:215], a[68:71], a[84:87], v[212:215]
    ds_read_b64_tr_b16 a[26:27], v12 offset:17152
    buffer_load_dwordx4 v57, s[52:55], s74 offen offset:3104 lds
    v_mfma_f32_16x16x32_bf16 v[216:219], a[68:71], a[88:91], v[216:219]
    ds_read_b64_tr_b16 a[28:29], v12 offset:17664
    v_mfma_f32_16x16x32_bf16 v[220:223], a[68:71], a[92:95], v[220:223]
    ds_read_b64_tr_b16 a[30:31], v12 offset:18176
    v_mfma_f32_16x16x32_bf16 v[224:227], a[72:75], a[80:83], v[224:227]
    s_add_u32 m0, s89, 25344
    s_lshl_b32 s75, s81, 13
    buffer_load_dwordx4 v58, s[64:67], s75 offen sc1 lds
    v_mfma_f32_16x16x32_bf16 v[228:231], a[72:75], a[84:87], v[228:231]
    v_mfma_f32_16x16x32_bf16 v[232:235], a[76:79], a[80:83], v[232:235]
    v_mfma_f32_16x16x32_bf16 v[236:239], a[76:79], a[84:87], v[236:239]
    buffer_load_dwordx4 v59, s[64:67], s75 offen offset:1056 sc1 lds
    s_waitcnt vmcnt(25) lgkmcnt(0)
    s_barrier
    s_mov_b32 s22, 0x40000
L_poll_4:
    s_cmp_eq_u32 s12, 16
    s_cbranch_scc1 L_polled_4
    s_load_dword s12, s[20:21], 0 glc
    s_sub_u32 s22, s22, 1
    s_waitcnt lgkmcnt(0)
    s_cbranch_scc0 L_poll_4
L_polled_4:
    v_mfma_f32_16x16x32_bf16 v[128:131], a[0:3], a[32:35], v[128:131]
    ds_read_b64_tr_b16 a[80:81], v14 offset:42240
    v_mfma_f32_16x16x32_bf16 v[132:135], a[0:3], a[36:39], v[132:135]
    ds_read_b64_tr_b16 a[82:83], v14 offset:42752
    v_mfma_f32_16x16x32_bf16 v[136:139], a[0:3], a[40:43], v[136:139]
    ds_read_b64_tr_b16 a[84:85], v15 offset:42240
    buffer_load_dwordx4 v[96:99], v19, s[64:67], 0 offen sc1
    v_mfma_f32_16x16x32_bf16 v[140:143], a[0:3], a[44:47], v[140:143]
    ds_read_b64_tr_b16 a[86:87], v15 offset:42752
    v_mfma_f32_16x16x32_bf16 v[144:147], a[4:7], a[32:35], v[144:147]
    ds_read_b64_tr_b16 a[88:89], v16 offset:42240
    v_mfma_f32_16x16x32_bf16 v[148:151], a[4:7], a[36:39], v[148:151]
    ds_read_b64_tr_b16 a[90:91], v16 offset:42752
    buffer_load_dwordx4 v[100:103], v19, s[64:67], s23 offen sc1
    v_mfma_f32_16x16x32_bf16 v[152:155], a[4:7], a[40:43], v[152:155]
    ds_read_b64_tr_b16 a[92:93], v17 offset:42240
    v_mfma_f32_16x16x32_bf16 v[156:159], a[4:7], a[44:47], v[156:159]
    ds_read_b64_tr_b16 a[94:95], v17 offset:42752
    v_mfma_f32_16x16x32_bf16 v[160:163], a[8:11], a[32:35], v[160:163]
    ds_read_b64_tr_b16 a[48:49], v9 offset:33280
    buffer_load_dwordx4 v[104:107], v1, s[64:67], 0 offen sc1
    v_mfma_f32_16x16x32_bf16 v[164:167], a[8:11], a[36:39], v[164:167]
    ds_read_b64_tr_b16 a[50:51], v9 offset:33792
    v_mfma_f32_16x16x32_bf16 v[168:171], a[8:11], a[40:43], v[168:171]
    ds_read_b64_tr_b16 a[52:53], v9 offset:34304
    v_mfma_f32_16x16x32_bf16 v[172:175], a[8:11], a[44:47], v[172:175]
    ds_read_b64_tr_b16 a[54:55], v9 offset:34816
    buffer_load_dwordx4 v[108:111], v1, s[64:67], s23 offen sc1
    v_mfma_f32_16x16x32_bf16 v[176:179], a[12:15], a[32:35], v[176:179]
    ds_read_b64_tr_b16 a[56:57], v9 offset:33312
    v_mfma_f32_16x16x32_bf16 v[180:183], a[12:15], a[36:39], v[180:183]
    ds_read_b64_tr_b16 a[58:59], v9 offset:33824
    s_add_u32 m0, s88, 66560
    s_add_u32 s74, s86, 0
    buffer_load_dwordx4 v62, s[56:59], s74 offen lds
    v_mfma_f32_16x16x32_bf16 v[184:187], a[12:15], a[40:43], v[184:187]
    ds_read_b64_tr_b16 a[60:61], v9 offset:34336
    v_mfma_f32_16x16x32_bf16 v[188:191], a[12:15], a[44:47], v[188:191]
    ds_read_b64_tr_b16 a[62:63], v9 offset:34848
    v_mfma_f32_16x16x32_bf16 v[192:195], a[16:19], a[32:35], v[192:195]
    ds_read_b64_tr_b16 a[64:65], v9 offset:33344
    s_add_u32 s74, s74, 7168
    buffer_load_dwordx4 v62, s[56:59], s74 offen offset:1024 lds
    v_mfma_f32_16x16x32_bf16 v[196:199], a[16:19], a[36:39], v[196:199]
    ds_read_b64_tr_b16 a[66:67], v9 offset:33856
    v_mfma_f32_16x16x32_bf16 v[200:203], a[16:19], a[40:43], v[200:203]
    ds_read_b64_tr_b16 a[68:69], v9 offset:34368
    v_mfma_f32_16x16x32_bf16 v[204:207], a[16:19], a[44:47], v[204:207]
    ds_read_b64_tr_b16 a[70:71], v9 offset:34880
    s_add_u32 m0, s88, 68608
    s_add_u32 s74, s86, 16384
    buffer_load_dwordx4 v62, s[56:59], s74 offen lds
    v_mfma_f32_16x16x32_bf16 v[208:211], a[20:23], a[32:35], v[208:211]
    ds_read_b64_tr_b16 a[72:73], v12 offset:33280
    v_mfma_f32_16x16x32_bf16 v[212:215], a[20:23], a[36:39], v[212:215]
    ds_read_b64_tr_b16 a[74:75], v12 offset:33792
    v_mfma_f32_16x16x32_bf16 v[216:219], a[20:23], a[40:43], v[216:219]
    ds_read_b64_tr_b16 a[76:77], v12 offset:34304
    s_add_u32 s74, s74, 7168
    buffer_load_dwordx4 v62, s[56:59], s74 offen offset:1024 lds
    v_mfma_f32_16x16x32_bf16 v[220:223], a[20:23], a[44:47], v[220:223]
    ds_read_b64_tr_b16 a[78:79], v12 offset:34816
    v_mfma_f32_16x16x32_bf16 v[224:227], a[24:27], a[32:35], v[224:227]
    v_mfma_f32_16x16x32_bf16 v[228:231], a[24:27], a[36:39], v[228:231]
    s_add_u32 m0, s89, 33792
    s_add_u32 s74, s86, 49152
    buffer_load_dwordx4 v62, s[56:59], s74 offen lds
    v_mfma_f32_16x16x32_bf16 v[232:235], a[28:31], a[32:35], v[232:235]
    v_mfma_f32_16x16x32_bf16 v[236:239], a[28:31], a[36:39], v[236:239]
    s_add_u32 s74, s74, 7168
    buffer_load_dwordx4 v62, s[56:59], s74 offen offset:1024 lds
    s_waitcnt vmcnt(28) lgkmcnt(0)
    s_barrier
    v_mfma_f32_16x16x32_bf16 v[128:131], a[48:51], a[80:83], v[128:131]
    ds_read_b64_tr_b16 a[32:33], v14 offset:0
    v_mfma_f32_16x16x32_bf16 v[132:135], a[48:51], a[84:87], v[132:135]
    ds_read_b64_tr_b16 a[34:35], v14 offset:512
    v_mfma_f32_16x16x32_bf16 v[136:139], a[48:51], a[88:91], v[136:139]
    ds_read_b64_tr_b16 a[36:37], v15 offset:0
    v_mfma_f32_16x16x32_bf16 v[140:143], a[48:51], a[92:95], v[140:143]
    ds_read_b64_tr_b16 a[38:39], v15 offset:512
    v_mfma_f32_16x16x32_bf16 v[144:147], a[52:55], a[80:83], v[144:147]
    ds_read_b64_tr_b16 a[40:41], v16 offset:0
    s_add_u32 m0, s88, 83200
    s_add_u32 s74, s86, 65536
    buffer_load_dwordx4 v62, s[56:59], s74 offen lds
    v_mfma_f32_16x16x32_bf16 v[148:151], a[52:55], a[84:87], v[148:151]
    ds_read_b64_tr_b16 a[42:43], v16 offset:512
    v_mfma_f32_16x16x32_bf16 v[152:155], a[52:55], a[88:91], v[152:155]
    ds_read_b64_tr_b16 a[44:45], v17 offset:0
    v_mfma_f32_16x16x32_bf16 v[156:159], a[52:55], a[92:95], v[156:159]
    ds_read_b64_tr_b16 a[46:47], v17 offset:512
    v_mfma_f32_16x16x32_bf16 v[160:163], a[56:59], a[80:83], v[160:163]
    ds_read_b64_tr_b16 a[0:1], v8 offset:0
    v_mfma_f32_16x16x32_bf16 v[164:167], a[56:59], a[84:87], v[164:167]
    ds_read_b64_tr_b16 a[2:3], v8 offset:512
    s_add_u32 s74, s74, 7168
    buffer_load_dwordx4 v62, s[56:59], s74 offen offset:1024 lds
    v_mfma_f32_16x16x32_bf16 v[168:171], a[56:59], a[88:91], v[168:171]
    ds_read_b64_tr_b16 a[4:5], v8 offset:1024
    v_mfma_f32_16x16x32_bf16 v[172:175], a[56:59], a[92:95], v[172:175]
    ds_read_b64_tr_b16 a[6:7], v8 offset:1536
    v_mfma_f32_16x16x32_bf16 v[176:179], a[60:63], a[80:83], v[176:179]
    ds_read_b64_tr_b16 a[8:9], v8 offset:32
    v_mfma_f32_16x16x32_bf16 v[180:183], a[60:63], a[84:87], v[180:183]
    ds_read_b64_tr_b16 a[10:11], v8 offset:544
    s_add_u32 m0, s88, 85248
    s_add_u32 s74, s86, 114688
    buffer_load_dwordx4 v62, s[56:59], s74 offen lds
    v_mfma_f32_16x16x32_bf16 v[184:187], a[60:63], a[88:91], v[184:187]
    ds_read_b64_tr_b16 a[12:13], v8 offset:1056
    v_mfma_f32_16x16x32_bf16 v[188:191], a[60:63], a[92:95], v[188:191]
    ds_read_b64_tr_b16 a[14:15], v8 offset:1568
    v_mfma_f32_16x16x32_bf16 v[192:195], a[64:67], a[80:83], v[192:195]
    ds_read_b64_tr_b16 a[16:17], v8 offset:64
    v_mfma_f32_16x16x32_bf16 v[196:199], a[64:67], a[84:87], v[196:199]
    ds_read_b64_tr_b16 a[18:19], v8 offset:576
    v_mfma_f32_16x16x32_bf16 v[200:203], a[64:67], a[88:91], v[200:203]
    ds_read_b64_tr_b16 a[20:21], v8 offset:1088
    s_add_u32 s74, s74, 7168
    buffer_load_dwordx4 v62, s[56:59], s74 offen offset:1024 lds
    v_mfma_f32_16x16x32_bf16 v[204:207], a[64:67], a[92:95], v[204:207]
    ds_read_b64_tr_b16 a[22:23], v8 offset:1600
    v_mfma_f32_16x16x32_bf16 v[208:211], a[68:71], a[80:83], v[208:211]
    ds_read_b64_tr_b16 a[24:25], v11 offset:0
    v_mfma_f32_16x16x32_bf16 v[212:215], a[68:71], a[84:87], v[212:215]
    ds_read_b64_tr_b16 a[26:27], v11 offset:512
    v_mfma_f32_16x16x32_bf16 v[216:219], a[68:71], a[88:91], v[216:219]
    ds_read_b64_tr_b16 a[28:29], v11 offset:1024
    v_mfma_f32_16x16x32_bf16 v[220:223], a[68:71], a[92:95], v[220:223]
    ds_read_b64_tr_b16 a[30:31], v11 offset:1536
    s_add_u32 m0, s89, 42240
    s_add_u32 s74, s86, 131072
    buffer_load_dwordx4 v62, s[56:59], s74 offen lds
    v_mfma_f32_16x16x32_bf16 v[224:227], a[72:75], a[80:83], v[224:227]
    v_mfma_f32_16x16x32_bf16 v[228:231], a[72:75], a[84:87], v[228:231]
    v_mfma_f32_16x16x32_bf16 v[232:235], a[76:79], a[80:83], v[232:235]
    v_mfma_f32_16x16x32_bf16 v[236:239], a[76:79], a[84:87], v[236:239]
    s_add_u32 s74, s74, 7168
    buffer_load_dwordx4 v62, s[56:59], s74 offen offset:1024 lds
    s_waitcnt vmcnt(12) lgkmcnt(0)
    s_barrier
    v_mfma_f32_16x16x32_bf16 v[128:131], a[0:3], a[32:35], v[128:131]
    ds_read_b64_tr_b16 a[80:81], v14 offset:8448
    v_add_f32 v96, v96, v100
    v_mfma_f32_16x16x32_bf16 v[132:135], a[0:3], a[36:39], v[132:135]
    ds_read_b64_tr_b16 a[82:83], v14 offset:8960
    v_add_f32 v97, v97, v101
    v_mfma_f32_16x16x32_bf16 v[136:139], a[0:3], a[40:43], v[136:139]
    ds_read_b64_tr_b16 a[84:85], v15 offset:8448
    v_add_f32 v98, v98, v102
    v_mfma_f32_16x16x32_bf16 v[140:143], a[0:3], a[44:47], v[140:143]
    ds_read_b64_tr_b16 a[86:87], v15 offset:8960
    v_add_f32 v99, v99, v103
    v_mfma_f32_16x16x32_bf16 v[144:147], a[4:7], a[32:35], v[144:147]
    ds_read_b64_tr_b16 a[88:89], v16 offset:8448
    v_add_f32 v104, v104, v108
    v_mfma_f32_16x16x32_bf16 v[148:151], a[4:7], a[36:39], v[148:151]
    ds_read_b64_tr_b16 a[90:91], v16 offset:8960
    v_add_f32 v105, v105, v109
    v_mfma_f32_16x16x32_bf16 v[152:155], a[4:7], a[40:43], v[152:155]
    ds_read_b64_tr_b16 a[92:93], v17 offset:8448
    v_add_f32 v106, v106, v110
    v_add_f32 v107, v107, v111
    v_mfma_f32_16x16x32_bf16 v[156:159], a[4:7], a[44:47], v[156:159]
    ds_read_b64_tr_b16 a[94:95], v17 offset:8960
    s_nop 0
    v_mfma_f32_16x16x32_bf16 v[160:163], a[8:11], a[32:35], v[160:163]
    ds_read_b64_tr_b16 a[48:49], v8 offset:16640
    v_permlane32_swap_b32 v96, v104
    v_mfma_f32_16x16x32_bf16 v[164:167], a[8:11], a[36:39], v[164:167]
    ds_read_b64_tr_b16 a[50:51], v8 offset:17152
    v_permlane32_swap_b32 v97, v105
    v_mfma_f32_16x16x32_bf16 v[168:171], a[8:11], a[40:43], v[168:171]
    ds_read_b64_tr_b16 a[52:53], v8 offset:17664
    v_permlane32_swap_b32 v98, v106
    v_mfma_f32_16x16x32_bf16 v[172:175], a[8:11], a[44:47], v[172:175]
    ds_read_b64_tr_b16 a[54:55], v8 offset:18176
    v_permlane32_swap_b32 v99, v107
    v_mfma_f32_16x16x32_bf16 v[176:179], a[12:15], a[32:35], v[176:179]
    ds_read_b64_tr_b16 a[56:57], v8 offset:16672
    v_add_f32 v96, v96, v104
    v_mfma_f32_16x16x32_bf16 v[180:183], a[12:15], a[36:39], v[180:183]
    ds_read_b64_tr_b16 a[58:59], v8 offset:17184
    v_add_f32 v97, v97, v105
    v_add_f32 v98, v98, v106
    v_mfma_f32_16x16x32_bf16 v[184:187], a[12:15], a[40:43], v[184:187]
    ds_read_b64_tr_b16 a[60:61], v8 offset:17696
    v_add_f32 v99, v99, v107
    v_mfma_f32_16x16x32_bf16 v[188:191], a[12:15], a[44:47], v[188:191]
    ds_read_b64_tr_b16 a[62:63], v8 offset:18208
    s_nop 1
    v_mfma_f32_16x16x32_bf16 v[192:195], a[16:19], a[32:35], v[192:195]
    ds_read_b64_tr_b16 a[64:65], v8 offset:16704
    v_permlane16_swap_b32 v96, v98
    v_mfma_f32_16x16x32_bf16 v[196:199], a[16:19], a[36:39], v[196:199]
    ds_read_b64_tr_b16 a[66:67], v8 offset:17216
    v_permlane16_swap_b32 v97, v99
    v_mfma_f32_16x16x32_bf16 v[200:203], a[16:19], a[40:43], v[200:203]
    ds_read_b64_tr_b16 a[68:69], v8 offset:17728
    s_nop 1
    v_mfma_f32_16x16x32_bf16 v[204:207], a[16:19], a[44:47], v[204:207]
    ds_read_b64_tr_b16 a[70:71], v8 offset:18240
    v_add_f32 v96, v96, v98
    v_mfma_f32_16x16x32_bf16 v[208:211], a[20:23], a[32:35], v[208:211]
    ds_read_b64_tr_b16 a[72:73], v11 offset:16640
    v_add_f32 v97, v97, v99
    s_nop 1
    v_mfma_f32_16x16x32_bf16 v[212:215], a[20:23], a[36:39], v[212:215]
    ds_read_b64_tr_b16 a[74:75], v11 offset:17152
    v_add_f32_dpp v96, v96, v96 row_ror:8 row_mask:0xf bank_mask:0xf
    v_mfma_f32_16x16x32_bf16 v[216:219], a[20:23], a[40:43], v[216:219]
    ds_read_b64_tr_b16 a[76:77], v11 offset:17664
    v_add_f32_dpp v97, v97, v97 row_ror:8 row_mask:0xf bank_mask:0xf
    v_mfma_f32_16x16x32_bf16 v[220:223], a[20:23], a[44:47], v[220:223]
    ds_read_b64_tr_b16 a[78:79], v11 offset:18176
    s_add_u32 m0, s88, 0
    s_add_u32 s74, s86, 163840
    buffer_load_dwordx4 v62, s[56:59], s74 offen lds
    v_mfma_f32_16x16x32_bf16 v[224:227], a[24:27], a[32:35], v[224:227]
    s_add_u32 s74, s74, 7168
    buffer_load_dwordx4 v62, s[56:59], s74 offen offset:1024 lds
    v_mfma_f32_16x16x32_bf16 v[228:231], a[24:27], a[36:39], v[228:231]
    s_add_u32 m0, s88, 2048
    s_add_u32 s74, s86, 180224
    buffer_load_dwordx4 v62, s[56:59], s74 offen lds
    v_mfma_f32_16x16x32_bf16 v[232:235], a[28:31], a[32:35], v[232:235]
    s_add_u32 s74, s74, 7168
    buffer_load_dwordx4 v62, s[56:59], s74 offen offset:1024 lds
    v_mfma_f32_16x16x32_bf16 v[236:239], a[28:31], a[36:39], v[236:239]
    s_add_u32 m0, s89, 0
    s_add_u32 s74, s86, 32768
    buffer_load_dwordx4 v62, s[56:59], s74 offen lds
    s_add_u32 s74, s74, 7168
    buffer_load_dwordx4 v62, s[56:59], s74 offen offset:1024 lds
    s_waitcnt lgkmcnt(0)
    s_barrier
    v_mfma_f32_16x16x32_bf16 v[128:131], a[48:51], a[80:83], v[128:131]
    ds_read_b64_tr_b16 a[32:33], v14 offset:16896
    v_mfma_f32_16x16x32_bf16 v[132:135], a[48:51], a[84:87], v[132:135]
    ds_read_b64_tr_b16 a[34:35], v14 offset:17408
    s_mov_b32 s76, 989855744
    v_mfma_f32_16x16x32_bf16 v[136:139], a[48:51], a[88:91], v[136:139]
    ds_read_b64_tr_b16 a[36:37], v15 offset:16896
    v_mul_f32 v96, s76, v96
    v_mfma_f32_16x16x32_bf16 v[140:143], a[48:51], a[92:95], v[140:143]
    ds_read_b64_tr_b16 a[38:39], v15 offset:17408
    v_mul_f32 v97, s76, v97
    v_mfma_f32_16x16x32_bf16 v[144:147], a[52:55], a[80:83], v[144:147]
    ds_read_b64_tr_b16 a[40:41], v16 offset:16896
    v_mfma_f32_16x16x32_bf16 v[148:151], a[52:55], a[84:87], v[148:151]
    ds_read_b64_tr_b16 a[42:43], v16 offset:17408
    v_fma_f32 v97, -v96, v96, v97
    v_mfma_f32_16x16x32_bf16 v[152:155], a[52:55], a[88:91], v[152:155]
    ds_read_b64_tr_b16 a[44:45], v17 offset:16896
    v_max_f32 v97, 0, v97
    v_mfma_f32_16x16x32_bf16 v[156:159], a[52:55], a[92:95], v[156:159]
    ds_read_b64_tr_b16 a[46:47], v17 offset:17408
    v_cvt_pk_bf16_f32 v97, v97, v97
    v_mfma_f32_16x16x32_bf16 v[160:163], a[56:59], a[80:83], v[160:163]
    ds_read_b64_tr_b16 a[0:1], v8 offset:33280
    v_and_b32 v97, 0xffff0000, v97
    v_mfma_f32_16x16x32_bf16 v[164:167], a[56:59], a[84:87], v[164:167]
    ds_read_b64_tr_b16 a[2:3], v8 offset:33792
    v_mfma_f32_16x16x32_bf16 v[168:171], a[56:59], a[88:91], v[168:171]
    ds_read_b64_tr_b16 a[4:5], v8 offset:34304
    v_add_f32 v97, 925353388, v97
    v_mfma_f32_16x16x32_bf16 v[172:175], a[56:59], a[92:95], v[172:175]
    ds_read_b64_tr_b16 a[6:7], v8 offset:34816
    v_cvt_pk_bf16_f32 v97, v97, v97
    v_mfma_f32_16x16x32_bf16 v[176:179], a[60:63], a[80:83], v[176:179]
    ds_read_b64_tr_b16 a[8:9], v8 offset:33312
    v_and_b32 v97, 0xffff0000, v97
    v_mfma_f32_16x16x32_bf16 v[180:183], a[60:63], a[84:87], v[180:183]
    ds_read_b64_tr_b16 a[10:11], v8 offset:33824
    v_sqrt_f32 v97, v97
    v_mfma_f32_16x16x32_bf16 v[184:187], a[60:63], a[88:91], v[184:187]
    ds_read_b64_tr_b16 a[12:13], v8 offset:34336
    v_mfma_f32_16x16x32_bf16 v[188:191], a[60:63], a[92:95], v[188:191]
    ds_read_b64_tr_b16 a[14:15], v8 offset:34848
    v_cvt_pk_bf16_f32 v96, v96, v96
    v_mfma_f32_16x16x32_bf16 v[192:195], a[64:67], a[80:83], v[192:195]
    ds_read_b64_tr_b16 a[16:17], v8 offset:33344
    v_and_b32 v96, 0xffff0000, v96
    v_mfma_f32_16x16x32_bf16 v[196:199], a[64:67], a[84:87], v[196:199]
    ds_read_b64_tr_b16 a[18:19], v8 offset:33856
    v_cvt_pk_bf16_f32 v97, v97, v97
    v_mfma_f32_16x16x32_bf16 v[200:203], a[64:67], a[88:91], v[200:203]
    ds_read_b64_tr_b16 a[20:21], v8 offset:34368
    v_mfma_f32_16x16x32_bf16 v[204:207], a[64:67], a[92:95], v[204:207]
    ds_read_b64_tr_b16 a[22:23], v8 offset:34880
    v_and_b32 v97, 0xffff0000, v97
    v_mfma_f32_16x16x32_bf16 v[208:211], a[68:71], a[80:83], v[208:211]
    ds_read_b64_tr_b16 a[24:25], v11 offset:33280
    ds_write_b64 v10, v[96:97]
    v_mfma_f32_16x16x32_bf16 v[212:215], a[68:71], a[84:87], v[212:215]
    ds_read_b64_tr_b16 a[26:27], v11 offset:33792
    s_add_u32 m0, s88, 16640
    s_add_u32 s74, s86, 81920
    buffer_load_dwordx4 v62, s[56:59], s74 offen lds
    v_mfma_f32_16x16x32_bf16 v[216:219], a[68:71], a[88:91], v[216:219]
    ds_read_b64_tr_b16 a[28:29], v11 offset:34304
    s_add_u32 s74, s74, 7168
    buffer_load_dwordx4 v62, s[56:59], s74 offen offset:1024 lds
    v_mfma_f32_16x16x32_bf16 v[220:223], a[68:71], a[92:95], v[220:223]
    ds_read_b64_tr_b16 a[30:31], v11 offset:34816
    v_mfma_f32_16x16x32_bf16 v[224:227], a[72:75], a[80:83], v[224:227]
    s_add_u32 m0, s88, 18688
    s_add_u32 s74, s86, 98304
    buffer_load_dwordx4 v62, s[56:59], s74 offen lds
    v_mfma_f32_16x16x32_bf16 v[228:231], a[72:75], a[84:87], v[228:231]
    s_add_u32 s74, s74, 7168
    buffer_load_dwordx4 v62, s[56:59], s74 offen offset:1024 lds
    v_mfma_f32_16x16x32_bf16 v[232:235], a[76:79], a[80:83], v[232:235]
    s_add_u32 m0, s89, 8448
    s_add_u32 s74, s86, 147456
    buffer_load_dwordx4 v62, s[56:59], s74 offen lds
    v_mfma_f32_16x16x32_bf16 v[236:239], a[76:79], a[84:87], v[236:239]
    s_add_u32 s74, s74, 7168
    buffer_load_dwordx4 v62, s[56:59], s74 offen offset:1024 lds
    s_waitcnt lgkmcnt(0)
    s_barrier
    v_mfma_f32_16x16x32_bf16 v[128:131], a[0:3], a[32:35], v[128:131]
    ds_read_b64_tr_b16 a[80:81], v14 offset:25344
    v_mfma_f32_16x16x32_bf16 v[132:135], a[0:3], a[36:39], v[132:135]
    ds_read_b64_tr_b16 a[82:83], v14 offset:25856
    v_xor_b32 v1, 128, v20
    v_mfma_f32_16x16x32_bf16 v[136:139], a[0:3], a[40:43], v[136:139]
    ds_read_b64_tr_b16 a[84:85], v15 offset:25344
    v_xor_b32 v2, 256, v20
    v_mfma_f32_16x16x32_bf16 v[140:143], a[0:3], a[44:47], v[140:143]
    ds_read_b64_tr_b16 a[86:87], v15 offset:25856
    v_xor_b32 v3, 384, v20
    v_mfma_f32_16x16x32_bf16 v[144:147], a[4:7], a[32:35], v[144:147]
    ds_read_b64_tr_b16 a[88:89], v16 offset:25344
    ds_read_b64 v[96:97], v20
    v_mfma_f32_16x16x32_bf16 v[148:151], a[4:7], a[36:39], v[148:151]
    ds_read_b64_tr_b16 a[90:91], v16 offset:25856
    v_mfma_f32_16x16x32_bf16 v[152:155], a[4:7], a[40:43], v[152:155]
    ds_read_b64_tr_b16 a[92:93], v17 offset:25344
    ds_read_b64 v[98:99], v1
    v_mfma_f32_16x16x32_bf16 v[156:159], a[4:7], a[44:47], v[156:159]
    ds_read_b64_tr_b16 a[94:95], v17 offset:25856
    ds_read_b64 v[100:101], v2
    v_mfma_f32_16x16x32_bf16 v[160:163], a[8:11], a[32:35], v[160:163]
    ds_read_b64_tr_b16 a[48:49], v9 offset:0
    ds_read_b64 v[102:103], v3
    v_mfma_f32_16x16x32_bf16 v[164:167], a[8:11], a[36:39], v[164:167]
    ds_read_b64_tr_b16 a[50:51], v9 offset:512
    s_mul_i32 s3, s82, 192
    v_mfma_f32_16x16x32_bf16 v[168:171], a[8:11], a[40:43], v[168:171]
    ds_read_b64_tr_b16 a[52:53], v9 offset:1024
    v_add_u32 v1, s3, v21
    v_mfma_f32_16x16x32_bf16 v[172:175], a[8:11], a[44:47], v[172:175]
    ds_read_b64_tr_b16 a[54:55], v9 offset:1536
    v_mfma_f32_16x16x32_bf16 v[176:179], a[12:15], a[32:35], v[176:179]
    ds_read_b64_tr_b16 a[56:57], v9 offset:32
    ds_read_b128 v[64:67], v1 offset:0
    v_mfma_f32_16x16x32_bf16 v[180:183], a[12:15], a[36:39], v[180:183]
    ds_read_b64_tr_b16 a[58:59], v9 offset:544
    ds_read_b128 v[68:71], v1 offset:448
    v_mfma_f32_16x16x32_bf16 v[184:187], a[12:15], a[40:43], v[184:187]
    ds_read_b64_tr_b16 a[60:61], v9 offset:1056
    ds_read_b128 v[72:75], v1 offset:64
    v_mfma_f32_16x16x32_bf16 v[188:191], a[12:15], a[44:47], v[188:191]
    ds_read_b64_tr_b16 a[62:63], v9 offset:1568
    ds_read_b128 v[76:79], v1 offset:512
    v_mfma_f32_16x16x32_bf16 v[192:195], a[16:19], a[32:35], v[192:195]
    ds_read_b64_tr_b16 a[64:65], v9 offset:64
    v_mfma_f32_16x16x32_bf16 v[196:199], a[16:19], a[36:39], v[196:199]
    ds_read_b64_tr_b16 a[66:67], v9 offset:576
    ds_read_b128 v[80:83], v1 offset:128
    v_mfma_f32_16x16x32_bf16 v[200:203], a[16:19], a[40:43], v[200:203]
    ds_read_b64_tr_b16 a[68:69], v9 offset:1088
    ds_read_b128 v[84:87], v1 offset:576
    v_mfma_f32_16x16x32_bf16 v[204:207], a[16:19], a[44:47], v[204:207]
    ds_read_b64_tr_b16 a[70:71], v9 offset:1600
    ds_read_b128 v[88:91], v21 offset:384
    v_mfma_f32_16x16x32_bf16 v[208:211], a[20:23], a[32:35], v[208:211]
    ds_read_b64_tr_b16 a[72:73], v12 offset:0
    ds_read_b128 v[92:95], v21 offset:832
    v_mfma_f32_16x16x32_bf16 v[212:215], a[20:23], a[36:39], v[212:215]
    ds_read_b64_tr_b16 a[74:75], v12 offset:512
    s_add_u32 m0, s88, 33280
    s_add_u32 s74, s86, 196608
    buffer_load_dwordx4 v62, s[56:59], s74 offen lds
    v_mfma_f32_16x16x32_bf16 v[216:219], a[20:23], a[40:43], v[216:219]
    ds_read_b64_tr_b16 a[76:77], v12 offset:1024
    v_mfma_f32_16x16x32_bf16 v[220:223], a[20:23], a[44:47], v[220:223]
    ds_read_b64_tr_b16 a[78:79], v12 offset:1536
    s_add_u32 s74, s74, 7168
    buffer_load_dwordx4 v62, s[56:59], s74 offen offset:1024 lds
    v_mfma_f32_16x16x32_bf16 v[224:227], a[24:27], a[32:35], v[224:227]
    s_add_u32 m0, s88, 35328
    s_add_u32 s74, s86, 212992
    buffer_load_dwordx4 v62, s[56:59], s74 offen lds
    v_mfma_f32_16x16x32_bf16 v[228:231], a[24:27], a[36:39], v[228:231]
    s_add_u32 s74, s74, 7168
    buffer_load_dwordx4 v62, s[56:59], s74 offen offset:1024 lds
    v_mfma_f32_16x16x32_bf16 v[232:235], a[28:31], a[32:35], v[232:235]
    s_add_u32 m0, s89, 16896
    s_add_u32 s74, s87, 0
    buffer_load_dwordx4 v62, s[56:59], s74 offen lds
    v_mfma_f32_16x16x32_bf16 v[236:239], a[28:31], a[36:39], v[236:239]
    s_add_u32 s74, s74, 7168
    buffer_load_dwordx4 v62, s[56:59], s74 offen offset:1024 lds
    s_waitcnt vmcnt(18) lgkmcnt(0)
    s_barrier
    v_mfma_f32_16x16x32_bf16 v[128:131], a[48:51], a[80:83], v[128:131]
    ds_read_b64_tr_b16 a[120:121], v48 offset:16640
    s_mov_b32 s4, 3222493025
    v_mfma_f32_16x16x32_bf16 v[132:135], a[48:51], a[84:87], v[132:135]
    ds_read_b64_tr_b16 a[150:151], v49 offset:16640
    s_mov_b32 s5, 3184710632
    v_mfma_f32_16x16x32_bf16 v[136:139], a[48:51], a[88:91], v[136:139]
    ds_read_b64_tr_b16 a[180:181], v50 offset:16640
    v_rcp_f32 v104, v97
    v_mfma_f32_16x16x32_bf16 v[140:143], a[48:51], a[92:95], v[140:143]
    ds_read_b64_tr_b16 a[210:211], v51 offset:16640
    v_rcp_f32 v105, v99
    v_rcp_f32 v106, v101
    v_mfma_f32_16x16x32_bf16 v[144:147], a[52:55], a[80:83], v[144:147]
    ds_read_b64_tr_b16 a[122:123], v48 offset:18688
    v_rcp_f32 v107, v103
    v_mfma_f32_16x16x32_bf16 v[148:151], a[52:55], a[84:87], v[148:151]
    ds_read_b64_tr_b16 a[152:153], v49 offset:18688
    v_sub_f32 v24, 0, v96
    v_mfma_f32_16x16x32_bf16 v[152:155], a[52:55], a[88:91], v[152:155]
    ds_read_b64_tr_b16 a[182:183], v50 offset:18688
    v_mul_f32 v27, v97, v97
    v_mul_f32 v25, s4, v104
    v_mfma_f32_16x16x32_bf16 v[156:159], a[52:55], a[92:95], v[156:159]
    ds_read_b64_tr_b16 a[212:213], v51 offset:18688
    v_mul_f32 v26, v104, v104
    v_mfma_f32_16x16x32_bf16 v[160:163], a[56:59], a[80:83], v[160:163]
    ds_read_b64_tr_b16 a[124:125], v52 offset:33792
    v_mul_f32 v26, v26, v104
    v_mfma_f32_16x16x32_bf16 v[164:167], a[56:59], a[84:87], v[164:167]
    ds_read_b64_tr_b16 a[154:155], v53 offset:33792
    v_mul_f32 v26, s5, v26
    v_mfma_f32_16x16x32_bf16 v[168:171], a[56:59], a[88:91], v[168:171]
    ds_read_b64_tr_b16 a[184:185], v54 offset:33792
    v_sub_f32 v28, 0, v98
    v_mul_f32 v31, v99, v99
    v_mfma_f32_16x16x32_bf16 v[172:175], a[56:59], a[92:95], v[172:175]
    ds_read_b64_tr_b16 a[214:215], v55 offset:33792
    v_mul_f32 v29, s4, v105
    v_mfma_f32_16x16x32_bf16 v[176:179], a[60:63], a[80:83], v[176:179]
    ds_read_b64_tr_b16 a[126:127], v48 offset:33280
    v_mul_f32 v30, v105, v105
    v_mfma_f32_16x16x32_bf16 v[180:183], a[60:63], a[84:87], v[180:183]
    ds_read_b64_tr_b16 a[156:157], v49 offset:33280
    v_mul_f32 v30, v30, v105
    v_mul_f32 v30, s5, v30
    v_mfma_f32_16x16x32_bf16 v[184:187], a[60:63], a[88:91], v[184:187]
    ds_read_b64_tr_b16 a[186:187], v50 offset:33280
    v_sub_f32 v32, 0, v100
    v_mfma_f32_16x16x32_bf16 v[188:191], a[60:63], a[92:95], v[188:191]
    ds_read_b64_tr_b16 a[216:217], v51 offset:33280
    v_mul_f32 v35, v101, v101
    v_mfma_f32_16x16x32_bf16 v[192:195], a[64:67], a[80:83], v[192:195]
    ds_read_b64_tr_b16 a[128:129], v48 offset:35328
    v_mul_f32 v33, s4, v106
    v_mfma_f32_16x16x32_bf16 v[196:199], a[64:67], a[84:87], v[196:199]
    ds_read_b64_tr_b16 a[158:159], v49 offset:35328
    v_mul_f32 v34, v106, v106
    v_mul_f32 v34, v34, v106
    v_mfma_f32_16x16x32_bf16 v[200:203], a[64:67], a[88:91], v[200:203]
    ds_read_b64_tr_b16 a[188:189], v50 offset:35328
    v_mul_f32 v34, s5, v34
    v_mfma_f32_16x16x32_bf16 v[204:207], a[64:67], a[92:95], v[204:207]
    ds_read_b64_tr_b16 a[218:219], v51 offset:35328
    v_sub_f32 v36, 0, v102
    v_mfma_f32_16x16x32_bf16 v[208:211], a[68:71], a[80:83], v[208:211]
    ds_read_b64_tr_b16 a[130:131], v52 offset:42240
    v_mul_f32 v39, v103, v103
    v_mul_f32 v37, s4, v107
    v_mfma_f32_16x16x32_bf16 v[212:215], a[68:71], a[84:87], v[212:215]
    ds_read_b64_tr_b16 a[160:161], v53 offset:42240
    v_mul_f32 v38, v107, v107
    v_mfma_f32_16x16x32_bf16 v[216:219], a[68:71], a[88:91], v[216:219]
    ds_read_b64_tr_b16 a[190:191], v54 offset:42240
    v_mul_f32 v38, v38, v107
    v_mfma_f32_16x16x32_bf16 v[220:223], a[68:71], a[92:95], v[220:223]
    ds_read_b64_tr_b16 a[220:221], v55 offset:42240
    v_mul_f32 v38, s5, v38
    v_mfma_f32_16x16x32_bf16 v[224:227], a[72:75], a[80:83], v[224:227]
    s_add_u32 m0, s88, 49920
    s_add_u32 s74, s87, 16384
    buffer_load_dwordx4 v62, s[56:59], s74 offen lds
    s_add_u32 s74, s74, 7168
    buffer_load_dwordx4 v62, s[56:59], s74 offen offset:1024 lds
    v_mfma_f32_16x16x32_bf16 v[228:231], a[72:75], a[84:87], v[228:231]
    s_add_u32 m0, s88, 51968
    s_add_u32 s74, s87, 49152
    buffer_load_dwordx4 v62, s[56:59], s74 offen lds
    v_mfma_f32_16x16x32_bf16 v[232:235], a[76:79], a[80:83], v[232:235]
    s_add_u32 s74, s74, 7168
    buffer_load_dwordx4 v62, s[56:59], s74 offen offset:1024 lds
    v_mfma_f32_16x16x32_bf16 v[236:239], a[76:79], a[84:87], v[236:239]
    s_add_u32 m0, s89, 25344
    s_add_u32 s74, s87, 65536
    buffer_load_dwordx4 v62, s[56:59], s74 offen lds
    s_add_u32 s74, s74, 7168
    buffer_load_dwordx4 v62, s[56:59], s74 offen offset:1024 lds
    s_mul_i32 s76, s24, 229376
    s_mul_i32 s3, s91, 7168
    s_add_u32 s76, s76, s3
    s_add_u32 s76, s76, 8388608
    s_mul_i32 s3, s82, 114688
    s_add_u32 s77, s76, s3
    s_sub_u32 s78, 114688, s3
    s_add_u32 s78, s78, s76
    s_lshl_b32 s3, s83, 10
    v_add_u32 v4, s3, v22
    v_xor_b32 v5, 1024, v4
    s_lshl_b32 s3, s82, 10
    s_add_u32 s3, s3, 4096
    v_add_u32 v6, s3, v22
    v_add_u32 v7, 6144, v22
    v_pk_fma_f32 v[224:225], v[24:25], v[88:89], v[224:225] op_sel:[0,0,0] op_sel_hi:[0,1,1]
    v_pk_fma_f32 v[226:227], v[24:25], v[90:91], v[226:227] op_sel:[0,0,0] op_sel_hi:[0,1,1]
    v_pk_mul_f32 v[40:41], v[224:225], v[224:225]
    v_pk_mul_f32 v[42:43], v[226:227], v[226:227]
    v_pk_fma_f32 v[40:41], v[40:41], v[26:27], v[24:25] op_sel:[0,0,1] op_sel_hi:[1,0,1]
    v_pk_fma_f32 v[42:43], v[42:43], v[26:27], v[24:25] op_sel:[0,0,1] op_sel_hi:[1,0,1]
    v_pk_mul_f32 v[40:41], v[40:41], v[224:225]
    v_pk_mul_f32 v[42:43], v[42:43], v[226:227]
    v_exp_f32 v40, v40
    v_pk_fma_f32 v[232:233], v[24:25], v[92:93], v[232:233] op_sel:[0,0,0] op_sel_hi:[0,1,1]
    v_exp_f32 v41, v41
    v_pk_fma_f32 v[234:235], v[24:25], v[94:95], v[234:235] op_sel:[0,0,0] op_sel_hi:[0,1,1]
    v_exp_f32 v42, v42
    v_pk_mul_f32 v[232:233], v[232:233], v[224:225]
    v_exp_f32 v43, v43
    v_pk_mul_f32 v[234:235], v[234:235], v[226:227]
    v_pk_fma_f32 v[40:41], v[40:41], v[26:27], v[26:27] op_sel:[0,1,1] op_sel_hi:[1,1,1]
    v_pk_fma_f32 v[42:43], v[42:43], v[26:27], v[26:27] op_sel:[0,1,1] op_sel_hi:[1,1,1]
    v_rcp_f32 v40, v40
    v_pk_fma_f32 v[228:229], v[28:29], v[88:89], v[228:229] op_sel:[0,0,0] op_sel_hi:[0,1,1]
    v_pk_fma_f32 v[230:231], v[28:29], v[90:91], v[230:231] op_sel:[0,0,0] op_sel_hi:[0,1,1]
    s_waitcnt vmcnt(16)
    ds_read_b64_tr_b16 a[132:133], v44 offset:0
    ds_read_b64_tr_b16 a[162:163], v45 offset:0
    v_rcp_f32 v41, v41
    v_pk_mul_f32 v[112:113], v[228:229], v[228:229]
    v_pk_mul_f32 v[114:115], v[230:231], v[230:231]
    ds_read_b64_tr_b16 a[192:193], v46 offset:0
    ds_read_b64_tr_b16 a[222:223], v47 offset:0
    ds_read_b64_tr_b16 a[134:135], v44 offset:2048
    v_rcp_f32 v42, v42
    v_pk_fma_f32 v[112:113], v[112:113], v[30:31], v[28:29] op_sel:[0,0,1] op_sel_hi:[1,0,1]
    v_pk_fma_f32 v[114:115], v[114:115], v[30:31], v[28:29] op_sel:[0,0,1] op_sel_hi:[1,0,1]
    ds_read_b64_tr_b16 a[164:165], v45 offset:2048
    ds_read_b64_tr_b16 a[194:195], v46 offset:2048
    ds_read_b64_tr_b16 a[224:225], v47 offset:2048
    v_rcp_f32 v43, v43
    v_pk_mul_f32 v[112:113], v[112:113], v[228:229]
    v_pk_mul_f32 v[114:115], v[114:115], v[230:231]
    ds_read_b64_tr_b16 a[136:137], v52 offset:0
    ds_read_b64_tr_b16 a[148:149], v52 offset:0
    ds_read_b64_tr_b16 a[166:167], v53 offset:0
    v_exp_f32 v112, v112
    v_pk_mul_f32 v[232:233], v[232:233], v[40:41]
    v_pk_fma_f32 v[236:237], v[28:29], v[92:93], v[236:237] op_sel:[0,0,0] op_sel_hi:[0,1,1]
    v_exp_f32 v113, v113
    v_pk_mul_f32 v[234:235], v[234:235], v[42:43]
    v_pk_fma_f32 v[238:239], v[28:29], v[94:95], v[238:239] op_sel:[0,0,0] op_sel_hi:[0,1,1]
    v_exp_f32 v114, v114
    v_cvt_pk_bf16_f32 v96, v232, v233
    v_pk_mul_f32 v[236:237], v[236:237], v[228:229]
    v_exp_f32 v115, v115
    v_cvt_pk_bf16_f32 v97, v234, v235
    v_pk_mul_f32 v[238:239], v[238:239], v[230:231]
    v_pk_fma_f32 v[112:113], v[112:113], v[30:31], v[30:31] op_sel:[0,1,1] op_sel_hi:[1,1,1]
    v_pk_fma_f32 v[114:115], v[114:115], v[30:31], v[30:31] op_sel:[0,1,1] op_sel_hi:[1,1,1]
    v_rcp_f32 v112, v112
    v_pk_fma_f32 v[192:193], v[24:25], v[80:81], v[192:193] op_sel:[0,0,0] op_sel_hi:[0,1,1]
    v_pk_fma_f32 v[194:195], v[24:25], v[82:83], v[194:195] op_sel:[0,0,0] op_sel_hi:[0,1,1]
    ds_read_b64_tr_b16 a[178:179], v53 offset:0
    ds_read_b64_tr_b16 a[196:197], v54 offset:0
    ds_read_b64_tr_b16 a[208:209], v54 offset:0
    v_rcp_f32 v113, v113
    v_pk_mul_f32 v[40:41], v[192:193], v[192:193]
    v_pk_mul_f32 v[42:43], v[194:195], v[194:195]
    ds_read_b64_tr_b16 a[226:227], v55 offset:0
    ds_read_b64_tr_b16 a[238:239], v55 offset:0
    ds_read_b64_tr_b16 a[138:139], v44 offset:16640
    v_rcp_f32 v114, v114
    v_pk_fma_f32 v[40:41], v[40:41], v[26:27], v[24:25] op_sel:[0,0,1] op_sel_hi:[1,0,1]
    v_pk_fma_f32 v[42:43], v[42:43], v[26:27], v[24:25] op_sel:[0,0,1] op_sel_hi:[1,0,1]
    ds_read_b64_tr_b16 a[168:169], v45 offset:16640
    ds_read_b64_tr_b16 a[198:199], v46 offset:16640
    ds_read_b64_tr_b16 a[228:229], v47 offset:16640
    v_rcp_f32 v115, v115
    v_pk_mul_f32 v[40:41], v[40:41], v[192:193]
    v_pk_mul_f32 v[42:43], v[42:43], v[194:195]
    s_waitcnt lgkmcnt(0)
    v_exp_f32 v40, v40
    v_pk_mul_f32 v[236:237], v[236:237], v[112:113]
    v_pk_fma_f32 v[208:209], v[24:25], v[84:85], v[208:209] op_sel:[0,0,0] op_sel_hi:[0,1,1]
    v_exp_f32 v41, v41
    v_pk_mul_f32 v[238:239], v[238:239], v[114:115]
    v_pk_fma_f32 v[210:211], v[24:25], v[86:87], v[210:211] op_sel:[0,0,0] op_sel_hi:[0,1,1]
    v_exp_f32 v42, v42
    v_cvt_pk_bf16_f32 v98, v236, v237
    v_pk_mul_f32 v[208:209], v[208:209], v[192:193]
    v_exp_f32 v43, v43
    v_cvt_pk_bf16_f32 v99, v238, v239
    v_pk_mul_f32 v[210:211], v[210:211], v[194:195]
    v_pk_fma_f32 v[40:41], v[40:41], v[26:27], v[26:27] op_sel:[0,1,1] op_sel_hi:[1,1,1]
    v_pk_fma_f32 v[42:43], v[42:43], v[26:27], v[26:27] op_sel:[0,1,1] op_sel_hi:[1,1,1]
    s_cmp_eq_u32 s82, 0
    s_cbranch_scc1 L_nosw6
    v_swap_b32 v96, v98
    v_swap_b32 v97, v99
L_nosw6:
    buffer_store_dwordx4 v[96:99], v7, s[64:67], s77 offen sc1
    v_rcp_f32 v40, v40
    v_pk_fma_f32 v[196:197], v[28:29], v[80:81], v[196:197] op_sel:[0,0,0] op_sel_hi:[0,1,1]
    v_pk_fma_f32 v[198:199], v[28:29], v[82:83], v[198:199] op_sel:[0,0,0] op_sel_hi:[0,1,1]
    s_add_u32 m0, s88, 66560
    s_add_u32 s74, s87, 114688
    buffer_load_dwordx4 v62, s[56:59], s74 offen lds
    v_rcp_f32 v41, v41
    v_pk_mul_f32 v[112:113], v[196:197], v[196:197]
    v_pk_mul_f32 v[114:115], v[198:199], v[198:199]
    s_add_u32 s74, s74, 7168
    buffer_load_dwordx4 v62, s[56:59], s74 offen offset:1024 lds
    v_rcp_f32 v42, v42
    v_pk_fma_f32 v[112:113], v[112:113], v[30:31], v[28:29] op_sel:[0,0,1] op_sel_hi:[1,0,1]
    v_pk_fma_f32 v[114:115], v[114:115], v[30:31], v[28:29] op_sel:[0,0,1] op_sel_hi:[1,0,1]
    v_rcp_f32 v43, v43
    v_pk_mul_f32 v[112:113], v[112:113], v[196:197]
    v_pk_mul_f32 v[114:115], v[114:115], v[198:199]
    v_exp_f32 v112, v112
    v_pk_mul_f32 v[208:209], v[208:209], v[40:41]
    v_pk_fma_f32 v[212:213], v[28:29], v[84:85], v[212:213] op_sel:[0,0,0] op_sel_hi:[0,1,1]
    v_exp_f32 v113, v113
    v_pk_mul_f32 v[210:211], v[210:211], v[42:43]
    v_pk_fma_f32 v[214:215], v[28:29], v[86:87], v[214:215] op_sel:[0,0,0] op_sel_hi:[0,1,1]
    v_exp_f32 v114, v114
    v_cvt_pk_bf16_f32 v100, v208, v209
    v_pk_mul_f32 v[212:213], v[212:213], v[196:197]
    v_exp_f32 v115, v115
    v_cvt_pk_bf16_f32 v101, v210, v211
    v_pk_mul_f32 v[214:215], v[214:215], v[198:199]
    v_pk_fma_f32 v[112:113], v[112:113], v[30:31], v[30:31] op_sel:[0,1,1] op_sel_hi:[1,1,1]
    v_pk_fma_f32 v[114:115], v[114:115], v[30:31], v[30:31] op_sel:[0,1,1] op_sel_hi:[1,1,1]
    v_rcp_f32 v112, v112
    v_pk_fma_f32 v[128:129], v[24:25], v[64:65], v[128:129] op_sel:[0,0,0] op_sel_hi:[0,1,1]
    v_pk_fma_f32 v[130:131], v[24:25], v[66:67], v[130:131] op_sel:[0,0,0] op_sel_hi:[0,1,1]
    s_add_u32 m0, s88, 68608
    s_add_u32 s74, s87, 131072
    buffer_load_dwordx4 v62, s[56:59], s74 offen lds
    v_rcp_f32 v113, v113
    v_pk_mul_f32 v[40:41], v[128:129], v[128:129]
    v_pk_mul_f32 v[42:43], v[130:131], v[130:131]
    s_add_u32 s74, s74, 7168
    buffer_load_dwordx4 v62, s[56:59], s74 offen offset:1024 lds
    v_rcp_f32 v114, v114
    v_pk_fma_f32 v[40:41], v[40:41], v[26:27], v[24:25] op_sel:[0,0,1] op_sel_hi:[1,0,1]
    v_pk_fma_f32 v[42:43], v[42:43], v[26:27], v[24:25] op_sel:[0,0,1] op_sel_hi:[1,0,1]
    v_rcp_f32 v115, v115
    v_pk_mul_f32 v[40:41], v[40:41], v[128:129]
    v_pk_mul_f32 v[42:43], v[42:43], v[130:131]
    v_exp_f32 v40, v40
    v_pk_mul_f32 v[212:213], v[212:213], v[112:113]
    v_pk_fma_f32 v[144:145], v[24:25], v[68:69], v[144:145] op_sel:[0,0,0] op_sel_hi:[0,1,1]
    v_exp_f32 v41, v41
    v_pk_mul_f32 v[214:215], v[214:215], v[114:115]
    v_pk_fma_f32 v[146:147], v[24:25], v[70:71], v[146:147] op_sel:[0,0,0] op_sel_hi:[0,1,1]
    v_exp_f32 v42, v42
    v_cvt_pk_bf16_f32 v102, v212, v213
    v_pk_mul_f32 v[144:145], v[144:145], v[128:129]
    v_exp_f32 v43, v43
    v_cvt_pk_bf16_f32 v103, v214, v215
    v_pk_mul_f32 v[146:147], v[146:147], v[130:131]
    v_pk_fma_f32 v[40:41], v[40:41], v[26:27], v[26:27] op_sel:[0,1,1] op_sel_hi:[1,1,1]
    v_pk_fma_f32 v[42:43], v[42:43], v[26:27], v[26:27] op_sel:[0,1,1] op_sel_hi:[1,1,1]
    buffer_store_dwordx4 v[100:103], v6, s[64:67], s77 offen sc1
    v_rcp_f32 v40, v40
    v_pk_fma_f32 v[160:161], v[24:25], v[72:73], v[160:161] op_sel:[0,0,0] op_sel_hi:[0,1,1]
    v_pk_fma_f32 v[162:163], v[24:25], v[74:75], v[162:163] op_sel:[0,0,0] op_sel_hi:[0,1,1]
    s_add_u32 m0, s89, 33792
    s_add_u32 s74, s87, 163840
    buffer_load_dwordx4 v62, s[56:59], s74 offen lds
    v_rcp_f32 v41, v41
    v_pk_mul_f32 v[112:113], v[160:161], v[160:161]
    v_pk_mul_f32 v[114:115], v[162:163], v[162:163]
    s_add_u32 s74, s74, 7168
    buffer_load_dwordx4 v62, s[56:59], s74 offen offset:1024 lds
    v_rcp_f32 v42, v42
    v_pk_fma_f32 v[112:113], v[112:113], v[26:27], v[24:25] op_sel:[0,0,1] op_sel_hi:[1,0,1]
    v_pk_fma_f32 v[114:115], v[114:115], v[26:27], v[24:25] op_sel:[0,0,1] op_sel_hi:[1,0,1]
    v_rcp_f32 v43, v43
    v_pk_mul_f32 v[112:113], v[112:113], v[160:161]
    v_pk_mul_f32 v[114:115], v[114:115], v[162:163]
    v_exp_f32 v112, v112
    v_pk_mul_f32 v[144:145], v[144:145], v[40:41]
    v_pk_fma_f32 v[176:177], v[24:25], v[76:77], v[176:177] op_sel:[0,0,0] op_sel_hi:[0,1,1]
    v_exp_f32 v113, v113
    v_pk_mul_f32 v[146:147], v[146:147], v[42:43]
    v_pk_fma_f32 v[178:179], v[24:25], v[78:79], v[178:179] op_sel:[0,0,0] op_sel_hi:[0,1,1]
    v_exp_f32 v114, v114
    v_cvt_pk_bf16_f32 v104, v144, v145
    v_pk_mul_f32 v[176:177], v[176:177], v[160:161]
    v_exp_f32 v115, v115
    v_cvt_pk_bf16_f32 v105, v146, v147
    v_pk_mul_f32 v[178:179], v[178:179], v[162:163]
    v_pk_fma_f32 v[112:113], v[112:113], v[26:27], v[26:27] op_sel:[0,1,1] op_sel_hi:[1,1,1]
    v_pk_fma_f32 v[114:115], v[114:115], v[26:27], v[26:27] op_sel:[0,1,1] op_sel_hi:[1,1,1]
    v_rcp_f32 v112, v112
    v_pk_fma_f32 v[132:133], v[28:29], v[64:65], v[132:133] op_sel:[0,0,0] op_sel_hi:[0,1,1]
    v_pk_fma_f32 v[134:135], v[28:29], v[66:67], v[134:135] op_sel:[0,0,0] op_sel_hi:[0,1,1]
    s_add_u32 m0, s88, 83200
    s_add_u32 s74, s87, 180224
    buffer_load_dwordx4 v62, s[56:59], s74 offen lds
    v_rcp_f32 v113, v113
    v_pk_mul_f32 v[40:41], v[132:133], v[132:133]
    v_pk_mul_f32 v[42:43], v[134:135], v[134:135]
    s_add_u32 s74, s74, 7168
    buffer_load_dwordx4 v62, s[56:59], s74 offen offset:1024 lds
    v_rcp_f32 v114, v114
    v_pk_fma_f32 v[40:41], v[40:41], v[30:31], v[28:29] op_sel:[0,0,1] op_sel_hi:[1,0,1]
    v_pk_fma_f32 v[42:43], v[42:43], v[30:31], v[28:29] op_sel:[0,0,1] op_sel_hi:[1,0,1]
    v_rcp_f32 v115, v115
    v_pk_mul_f32 v[40:41], v[40:41], v[132:133]
    v_pk_mul_f32 v[42:43], v[42:43], v[134:135]
    v_exp_f32 v40, v40
    v_pk_mul_f32 v[176:177], v[176:177], v[112:113]
    v_pk_fma_f32 v[148:149], v[28:29], v[68:69], v[148:149] op_sel:[0,0,0] op_sel_hi:[0,1,1]
    v_exp_f32 v41, v41
    v_pk_mul_f32 v[178:179], v[178:179], v[114:115]
    v_pk_fma_f32 v[150:151], v[28:29], v[70:71], v[150:151] op_sel:[0,0,0] op_sel_hi:[0,1,1]
    v_exp_f32 v42, v42
    v_cvt_pk_bf16_f32 v106, v176, v177
    v_pk_mul_f32 v[148:149], v[148:149], v[132:133]
    v_exp_f32 v43, v43
    v_cvt_pk_bf16_f32 v107, v178, v179
    v_pk_mul_f32 v[150:151], v[150:151], v[134:135]
    v_pk_fma_f32 v[40:41], v[40:41], v[30:31], v[30:31] op_sel:[0,1,1] op_sel_hi:[1,1,1]
    v_pk_fma_f32 v[42:43], v[42:43], v[30:31], v[30:31] op_sel:[0,1,1] op_sel_hi:[1,1,1]
    buffer_store_dwordx4 v[104:107], v4, s[64:67], s77 offen sc1
    v_rcp_f32 v40, v40
    v_pk_fma_f32 v[164:165], v[28:29], v[72:73], v[164:165] op_sel:[0,0,0] op_sel_hi:[0,1,1]
    v_pk_fma_f32 v[166:167], v[28:29], v[74:75], v[166:167] op_sel:[0,0,0] op_sel_hi:[0,1,1]
    s_add_u32 m0, s88, 85248
    s_add_u32 s74, s87, 32768
    buffer_load_dwordx4 v62, s[56:59], s74 offen lds
    v_rcp_f32 v41, v41
    v_pk_mul_f32 v[112:113], v[164:165], v[164:165]
    v_pk_mul_f32 v[114:115], v[166:167], v[166:167]
    s_add_u32 s74, s74, 7168
    buffer_load_dwordx4 v62, s[56:59], s74 offen offset:1024 lds
    v_rcp_f32 v42, v42
    v_pk_fma_f32 v[112:113], v[112:113], v[30:31], v[28:29] op_sel:[0,0,1] op_sel_hi:[1,0,1]
    v_pk_fma_f32 v[114:115], v[114:115], v[30:31], v[28:29] op_sel:[0,0,1] op_sel_hi:[1,0,1]
    v_rcp_f32 v43, v43
    v_pk_mul_f32 v[112:113], v[112:113], v[164:165]
    v_pk_mul_f32 v[114:115], v[114:115], v[166:167]
    v_exp_f32 v112, v112
    v_pk_mul_f32 v[148:149], v[148:149], v[40:41]
    v_pk_fma_f32 v[180:181], v[28:29], v[76:77], v[180:181] op_sel:[0,0,0] op_sel_hi:[0,1,1]
    v_exp_f32 v113, v113
    v_pk_mul_f32 v[150:151], v[150:151], v[42:43]
    v_pk_fma_f32 v[182:183], v[28:29], v[78:79], v[182:183] op_sel:[0,0,0] op_sel_hi:[0,1,1]
    v_exp_f32 v114, v114
    v_cvt_pk_bf16_f32 v108, v148, v149
    v_pk_mul_f32 v[180:181], v[180:181], v[164:165]
    v_exp_f32 v115, v115
    v_cvt_pk_bf16_f32 v109, v150, v151
    v_pk_mul_f32 v[182:183], v[182:183], v[166:167]
    v_pk_fma_f32 v[112:113], v[112:113], v[30:31], v[30:31] op_sel:[0,1,1] op_sel_hi:[1,1,1]
    v_pk_fma_f32 v[114:115], v[114:115], v[30:31], v[30:31] op_sel:[0,1,1] op_sel_hi:[1,1,1]
    v_rcp_f32 v112, v112
    v_pk_fma_f32 v[200:201], v[32:33], v[80:81], v[200:201] op_sel:[0,0,0] op_sel_hi:[0,1,1]
    v_pk_fma_f32 v[202:203], v[32:33], v[82:83], v[202:203] op_sel:[0,0,0] op_sel_hi:[0,1,1]
    v_rcp_f32 v113, v113
    v_pk_mul_f32 v[40:41], v[200:201], v[200:201]
    v_pk_mul_f32 v[42:43], v[202:203], v[202:203]
    v_rcp_f32 v114, v114
    v_pk_fma_f32 v[40:41], v[40:41], v[34:35], v[32:33] op_sel:[0,0,1] op_sel_hi:[1,0,1]
    v_pk_fma_f32 v[42:43], v[42:43], v[34:35], v[32:33] op_sel:[0,0,1] op_sel_hi:[1,0,1]
    v_rcp_f32 v115, v115
    v_pk_mul_f32 v[40:41], v[40:41], v[200:201]
    v_pk_mul_f32 v[42:43], v[42:43], v[202:203]
    v_exp_f32 v40, v40
    v_pk_mul_f32 v[180:181], v[180:181], v[112:113]
    v_pk_fma_f32 v[216:217], v[32:33], v[84:85], v[216:217] op_sel:[0,0,0] op_sel_hi:[0,1,1]
    v_exp_f32 v41, v41
    v_pk_mul_f32 v[182:183], v[182:183], v[114:115]
    v_pk_fma_f32 v[218:219], v[32:33], v[86:87], v[218:219] op_sel:[0,0,0] op_sel_hi:[0,1,1]
    v_exp_f32 v42, v42
    v_cvt_pk_bf16_f32 v110, v180, v181
    v_pk_mul_f32 v[216:217], v[216:217], v[200:201]
    v_exp_f32 v43, v43
    v_cvt_pk_bf16_f32 v111, v182, v183
    v_pk_mul_f32 v[218:219], v[218:219], v[202:203]
    v_pk_fma_f32 v[40:41], v[40:41], v[34:35], v[34:35] op_sel:[0,1,1] op_sel_hi:[1,1,1]
    v_pk_fma_f32 v[42:43], v[42:43], v[34:35], v[34:35] op_sel:[0,1,1] op_sel_hi:[1,1,1]
    buffer_store_dwordx4 v[108:111], v5, s[64:67], s77 offen sc1
    v_rcp_f32 v40, v40
    v_pk_fma_f32 v[204:205], v[36:37], v[80:81], v[204:205] op_sel:[0,0,0] op_sel_hi:[0,1,1]
    v_pk_fma_f32 v[206:207], v[36:37], v[82:83], v[206:207] op_sel:[0,0,0] op_sel_hi:[0,1,1]
    v_rcp_f32 v41, v41
    v_pk_mul_f32 v[112:113], v[204:205], v[204:205]
    v_pk_mul_f32 v[114:115], v[206:207], v[206:207]
    v_rcp_f32 v42, v42
    v_pk_fma_f32 v[112:113], v[112:113], v[38:39], v[36:37] op_sel:[0,0,1] op_sel_hi:[1,0,1]
    v_pk_fma_f32 v[114:115], v[114:115], v[38:39], v[36:37] op_sel:[0,0,1] op_sel_hi:[1,0,1]
    v_rcp_f32 v43, v43
    v_pk_mul_f32 v[112:113], v[112:113], v[204:205]
    v_pk_mul_f32 v[114:115], v[114:115], v[206:207]
    v_exp_f32 v112, v112
    v_pk_mul_f32 v[216:217], v[216:217], v[40:41]
    v_pk_fma_f32 v[220:221], v[36:37], v[84:85], v[220:221] op_sel:[0,0,0] op_sel_hi:[0,1,1]
    v_exp_f32 v113, v113
    v_pk_mul_f32 v[218:219], v[218:219], v[42:43]
    v_pk_fma_f32 v[222:223], v[36:37], v[86:87], v[222:223] op_sel:[0,0,0] op_sel_hi:[0,1,1]
    v_exp_f32 v114, v114
    v_cvt_pk_bf16_f32 v96, v216, v217
    v_pk_mul_f32 v[220:221], v[220:221], v[204:205]
    v_exp_f32 v115, v115
    v_cvt_pk_bf16_f32 v97, v218, v219
    v_pk_mul_f32 v[222:223], v[222:223], v[206:207]
    v_pk_fma_f32 v[112:113], v[112:113], v[38:39], v[38:39] op_sel:[0,1,1] op_sel_hi:[1,1,1]
    v_pk_fma_f32 v[114:115], v[114:115], v[38:39], v[38:39] op_sel:[0,1,1] op_sel_hi:[1,1,1]
    v_rcp_f32 v112, v112
    v_pk_fma_f32 v[136:137], v[32:33], v[64:65], v[136:137] op_sel:[0,0,0] op_sel_hi:[0,1,1]
    v_pk_fma_f32 v[138:139], v[32:33], v[66:67], v[138:139] op_sel:[0,0,0] op_sel_hi:[0,1,1]
    v_rcp_f32 v113, v113
    v_pk_mul_f32 v[40:41], v[136:137], v[136:137]
    v_pk_mul_f32 v[42:43], v[138:139], v[138:139]
    v_rcp_f32 v114, v114
    v_pk_fma_f32 v[40:41], v[40:41], v[34:35], v[32:33] op_sel:[0,0,1] op_sel_hi:[1,0,1]
    v_pk_fma_f32 v[42:43], v[42:43], v[34:35], v[32:33] op_sel:[0,0,1] op_sel_hi:[1,0,1]
    v_rcp_f32 v115, v115
    v_pk_mul_f32 v[40:41], v[40:41], v[136:137]
    v_pk_mul_f32 v[42:43], v[42:43], v[138:139]
    v_exp_f32 v40, v40
    v_pk_mul_f32 v[220:221], v[220:221], v[112:113]
    v_pk_fma_f32 v[152:153], v[32:33], v[68:69], v[152:153] op_sel:[0,0,0] op_sel_hi:[0,1,1]
    v_exp_f32 v41, v41
    v_pk_mul_f32 v[222:223], v[222:223], v[114:115]
    v_pk_fma_f32 v[154:155], v[32:33], v[70:71], v[154:155] op_sel:[0,0,0] op_sel_hi:[0,1,1]
    v_exp_f32 v42, v42
    v_cvt_pk_bf16_f32 v98, v220, v221
    v_pk_mul_f32 v[152:153], v[152:153], v[136:137]
    v_exp_f32 v43, v43
    v_cvt_pk_bf16_f32 v99, v222, v223
    v_pk_mul_f32 v[154:155], v[154:155], v[138:139]
    v_pk_fma_f32 v[40:41], v[40:41], v[34:35], v[34:35] op_sel:[0,1,1] op_sel_hi:[1,1,1]
    v_pk_fma_f32 v[42:43], v[42:43], v[34:35], v[34:35] op_sel:[0,1,1] op_sel_hi:[1,1,1]
    buffer_store_dwordx4 v[96:99], v6, s[64:67], s78 offen sc1
    v_rcp_f32 v40, v40
    v_pk_fma_f32 v[168:169], v[32:33], v[72:73], v[168:169] op_sel:[0,0,0] op_sel_hi:[0,1,1]
    v_pk_fma_f32 v[170:171], v[32:33], v[74:75], v[170:171] op_sel:[0,0,0] op_sel_hi:[0,1,1]
    v_rcp_f32 v41, v41
    v_pk_mul_f32 v[112:113], v[168:169], v[168:169]
    v_pk_mul_f32 v[114:115], v[170:171], v[170:171]
    v_rcp_f32 v42, v42
    v_pk_fma_f32 v[112:113], v[112:113], v[34:35], v[32:33] op_sel:[0,0,1] op_sel_hi:[1,0,1]
    v_pk_fma_f32 v[114:115], v[114:115], v[34:35], v[32:33] op_sel:[0,0,1] op_sel_hi:[1,0,1]
    v_rcp_f32 v43, v43
    v_pk_mul_f32 v[112:113], v[112:113], v[168:169]
    v_pk_mul_f32 v[114:115], v[114:115], v[170:171]
    v_exp_f32 v112, v112
    v_pk_mul_f32 v[152:153], v[152:153], v[40:41]
    v_pk_fma_f32 v[184:185], v[32:33], v[76:77], v[184:185] op_sel:[0,0,0] op_sel_hi:[0,1,1]
    v_exp_f32 v113, v113
    v_pk_mul_f32 v[154:155], v[154:155], v[42:43]
    v_pk_fma_f32 v[186:187], v[32:33], v[78:79], v[186:187] op_sel:[0,0,0] op_sel_hi:[0,1,1]
    v_exp_f32 v114, v114
    v_cvt_pk_bf16_f32 v100, v152, v153
    v_pk_mul_f32 v[184:185], v[184:185], v[168:169]
    v_exp_f32 v115, v115
    v_cvt_pk_bf16_f32 v101, v154, v155
    v_pk_mul_f32 v[186:187], v[186:187], v[170:171]
    v_pk_fma_f32 v[112:113], v[112:113], v[34:35], v[34:35] op_sel:[0,1,1] op_sel_hi:[1,1,1]
    v_pk_fma_f32 v[114:115], v[114:115], v[34:35], v[34:35] op_sel:[0,1,1] op_sel_hi:[1,1,1]
    v_rcp_f32 v112, v112
    v_pk_fma_f32 v[140:141], v[36:37], v[64:65], v[140:141] op_sel:[0,0,0] op_sel_hi:[0,1,1]
    v_pk_fma_f32 v[142:143], v[36:37], v[66:67], v[142:143] op_sel:[0,0,0] op_sel_hi:[0,1,1]
    v_rcp_f32 v113, v113
    v_pk_mul_f32 v[40:41], v[140:141], v[140:141]
    v_pk_mul_f32 v[42:43], v[142:143], v[142:143]
    v_rcp_f32 v114, v114
    v_pk_fma_f32 v[40:41], v[40:41], v[38:39], v[36:37] op_sel:[0,0,1] op_sel_hi:[1,0,1]
    v_pk_fma_f32 v[42:43], v[42:43], v[38:39], v[36:37] op_sel:[0,0,1] op_sel_hi:[1,0,1]
    v_rcp_f32 v115, v115
    v_pk_mul_f32 v[40:41], v[40:41], v[140:141]
    v_pk_mul_f32 v[42:43], v[42:43], v[142:143]
    v_exp_f32 v40, v40
    v_pk_mul_f32 v[184:185], v[184:185], v[112:113]
    v_pk_fma_f32 v[156:157], v[36:37], v[68:69], v[156:157] op_sel:[0,0,0] op_sel_hi:[0,1,1]
    v_exp_f32 v41, v41
    v_pk_mul_f32 v[186:187], v[186:187], v[114:115]
    v_pk_fma_f32 v[158:159], v[36:37], v[70:71], v[158:159] op_sel:[0,0,0] op_sel_hi:[0,1,1]
    v_exp_f32 v42, v42
    v_cvt_pk_bf16_f32 v102, v184, v185
    v_pk_mul_f32 v[156:157], v[156:157], v[140:141]
    v_exp_f32 v43, v43
    v_cvt_pk_bf16_f32 v103, v186, v187
    v_pk_mul_f32 v[158:159], v[158:159], v[142:143]
    v_pk_fma_f32 v[40:41], v[40:41], v[38:39], v[38:39] op_sel:[0,1,1] op_sel_hi:[1,1,1]
    v_pk_fma_f32 v[42:43], v[42:43], v[38:39], v[38:39] op_sel:[0,1,1] op_sel_hi:[1,1,1]
    buffer_store_dwordx4 v[100:103], v4, s[64:67], s78 offen sc1
    v_rcp_f32 v40, v40
    v_pk_fma_f32 v[172:173], v[36:37], v[72:73], v[172:173] op_sel:[0,0,0] op_sel_hi:[0,1,1]
    v_pk_fma_f32 v[174:175], v[36:37], v[74:75], v[174:175] op_sel:[0,0,0] op_sel_hi:[0,1,1]
    v_rcp_f32 v41, v41
    v_pk_mul_f32 v[112:113], v[172:173], v[172:173]
    v_pk_mul_f32 v[114:115], v[174:175], v[174:175]
    v_rcp_f32 v42, v42
    v_pk_fma_f32 v[112:113], v[112:113], v[38:39], v[36:37] op_sel:[0,0,1] op_sel_hi:[1,0,1]
    v_pk_fma_f32 v[114:115], v[114:115], v[38:39], v[36:37] op_sel:[0,0,1] op_sel_hi:[1,0,1]
    v_rcp_f32 v43, v43
    v_pk_mul_f32 v[112:113], v[112:113], v[172:173]
    v_pk_mul_f32 v[114:115], v[114:115], v[174:175]
    v_exp_f32 v112, v112
    v_pk_mul_f32 v[156:157], v[156:157], v[40:41]
    v_pk_fma_f32 v[188:189], v[36:37], v[76:77], v[188:189] op_sel:[0,0,0] op_sel_hi:[0,1,1]
    v_exp_f32 v113, v113
    v_pk_mul_f32 v[158:159], v[158:159], v[42:43]
    v_pk_fma_f32 v[190:191], v[36:37], v[78:79], v[190:191] op_sel:[0,0,0] op_sel_hi:[0,1,1]
    v_exp_f32 v114, v114
    v_cvt_pk_bf16_f32 v104, v156, v157
    v_pk_mul_f32 v[188:189], v[188:189], v[172:173]
    v_exp_f32 v115, v115
    v_cvt_pk_bf16_f32 v105, v158, v159
    v_pk_mul_f32 v[190:191], v[190:191], v[174:175]
    v_pk_fma_f32 v[112:113], v[112:113], v[38:39], v[38:39] op_sel:[0,1,1] op_sel_hi:[1,1,1]
    v_pk_fma_f32 v[114:115], v[114:115], v[38:39], v[38:39] op_sel:[0,1,1] op_sel_hi:[1,1,1]
    v_rcp_f32 v112, v112
    v_rcp_f32 v113, v113
    v_rcp_f32 v114, v114
    v_rcp_f32 v115, v115
    s_nop 0
    v_pk_mul_f32 v[188:189], v[188:189], v[112:113]
    v_pk_mul_f32 v[190:191], v[190:191], v[114:115]
    v_cvt_pk_bf16_f32 v106, v188, v189
    v_cvt_pk_bf16_f32 v107, v190, v191
    buffer_store_dwordx4 v[104:107], v5, s[64:67], s78 offen sc1
    s_waitcnt vmcnt(17)
    ds_read_b64_tr_b16 a[140:141], v44 offset:18688
    ds_read_b64_tr_b16 a[170:171], v45 offset:18688
    ds_read_b64_tr_b16 a[200:201], v46 offset:18688
    ds_read_b64_tr_b16 a[230:231], v47 offset:18688
    ds_read_b64_tr_b16 a[142:143], v52 offset:8448
    ds_read_b64_tr_b16 a[172:173], v53 offset:8448
    ds_read_b64_tr_b16 a[202:203], v54 offset:8448
    ds_read_b64_tr_b16 a[232:233], v55 offset:8448
    ds_read_b64_tr_b16 a[144:145], v44 offset:33280
    ds_read_b64_tr_b16 a[174:175], v45 offset:33280
    ds_read_b64_tr_b16 a[204:205], v46 offset:33280
    ds_read_b64_tr_b16 a[234:235], v47 offset:33280
    ds_read_b64_tr_b16 a[146:147], v44 offset:35328
    ds_read_b64_tr_b16 a[176:177], v45 offset:35328
    ds_read_b64_tr_b16 a[206:207], v46 offset:35328
    ds_read_b64_tr_b16 a[236:237], v47 offset:35328
    ds_read_b64_tr_b16 a[0:1], v52 offset:16896
    ds_read_b64_tr_b16 a[30:31], v53 offset:16896
    ds_read_b64_tr_b16 a[60:61], v54 offset:16896
    ds_read_b64_tr_b16 a[90:91], v55 offset:16896
    ds_read_b64_tr_b16 a[2:3], v48 offset:0
    ds_read_b64_tr_b16 a[32:33], v49 offset:0
    ds_read_b64_tr_b16 a[62:63], v50 offset:0
    ds_read_b64_tr_b16 a[92:93], v51 offset:0
    ds_read_b64_tr_b16 a[4:5], v48 offset:2048
    ds_read_b64_tr_b16 a[34:35], v49 offset:2048
    ds_read_b64_tr_b16 a[64:65], v50 offset:2048
    ds_read_b64_tr_b16 a[94:95], v51 offset:2048
    ds_read_b64_tr_b16 a[6:7], v52 offset:25344
    ds_read_b64_tr_b16 a[36:37], v53 offset:25344
    ds_read_b64_tr_b16 a[66:67], v54 offset:25344
    ds_read_b64_tr_b16 a[96:97], v55 offset:25344
    s_and_b32 s23, s85, 1
    s_lshl_b32 s3, s84, 1
    s_add_u32 s3, s3, s23
    s_lshl_b32 s3, s3, 3
    s_add_u32 s74, s3, s25
    s_xor_b32 s3, s74, 0
    s_mul_i32 s4, s3, 14336
    s_add_u32 s4, s4, 8388608
    s_xor_b32 s3, s74, 1
    s_mul_i32 s5, s3, 14336
    s_add_u32 s5, s5, 8388608
    s_xor_b32 s3, s74, 8
    s_mul_i32 s6, s3, 14336
    s_add_u32 s6, s6, 8388608
    s_xor_b32 s3, s74, 9
    s_mul_i32 s7, s3, 14336
    s_add_u32 s7, s7, 8388608
    v_add_u32 v8, 4096, v22
    v_add_u32 v9, 8192, v22
    v_add_u32 v10, 12288, v22
    s_lshl_b32 s3, s84, 3
    s_add_u32 s3, s3, s85
    s_lshl_b32 s3, s3, 2
    s_add_u32 s3, s3, s30
    s_lshl_b32 s3, s3, 8
    s_add_u32 s3, s3, 6684672
    s_add_u32 s20, s64, s3
    s_addc_u32 s21, s65, 0
    s_lshl_b32 s3, s24, 5
    s_lshr_b32 s74, s91, 2
    s_add_u32 s3, s3, s74
    s_lshl_b32 s3, s3, 8
    s_add_u32 s3, s3, 6684672
    v_mov_b32 v2, 1
    v_lshlrev_b32 v3, 10, v0
    s_mov_b64 exec, 0xff
    s_waitcnt vmcnt(0)
L_drained:
    buffer_atomic_add v2, v3, s[64:67], s3 offen sc1
    s_mov_b64 exec, -1
    s_add_u32 m0, s89, 42240
    s_add_u32 s74, s87, 81920
    buffer_load_dwordx4 v62, s[56:59], s74 offen lds
    s_add_u32 s74, s74, 7168
    buffer_load_dwordx4 v62, s[56:59], s74 offen offset:1024 lds
    s_add_u32 m0, s88, 0
    s_add_u32 s74, s87, 98304
    buffer_load_dwordx4 v62, s[56:59], s74 offen lds
    s_add_u32 s74, s74, 7168
    buffer_load_dwordx4 v62, s[56:59], s74 offen offset:1024 lds
    s_add_u32 m0, s88, 2048
    s_add_u32 s74, s87, 147456
    buffer_load_dwordx4 v62, s[56:59], s74 offen lds
    s_add_u32 s74, s74, 7168
    buffer_load_dwordx4 v62, s[56:59], s74 offen offset:1024 lds
    s_add_u32 m0, s89, 0
    s_add_u32 s74, s87, 196608
    buffer_load_dwordx4 v62, s[56:59], s74 offen lds
    s_add_u32 s74, s74, 7168
    buffer_load_dwordx4 v62, s[56:59], s74 offen offset:1024 lds
    s_add_u32 m0, s88, 16640
    s_add_u32 s74, s87, 212992
    buffer_load_dwordx4 v62, s[56:59], s74 offen lds
    s_add_u32 s74, s74, 7168
    buffer_load_dwordx4 v62, s[56:59], s74 offen offset:1024 lds
    s_mov_b32 s22, 0x40000
L_poll_3:
    s_load_dword s12, s[20:21], 0 glc
    s_sub_u32 s22, s22, 1
    s_waitcnt lgkmcnt(0)
    s_cbranch_scc1 L_polled_3
    s_cmp_lg_u32 s12, 8
    s_cbranch_scc1 L_poll_3
L_polled_3:
L_fast:
    buffer_load_dwordx4 v[128:131], v22, s[64:67], s4 offen offset:0 sc1
    buffer_load_dwordx4 v[132:135], v22, s[64:67], s4 offen offset:1024 sc1
    buffer_load_dwordx4 v[136:139], v22, s[64:67], s4 offen offset:2048 sc1
    buffer_load_dwordx4 v[140:143], v22, s[64:67], s4 offen offset:3072 sc1
    buffer_load_dwordx4 v[144:147], v8, s[64:67], s4 offen offset:3072 sc1
    buffer_load_dwordx4 v[148:151], v9, s[64:67], s4 offen offset:0 sc1
    buffer_load_dwordx4 v[152:155], v9, s[64:67], s4 offen offset:1024 sc1
    buffer_load_dwordx4 v[156:159], v9, s[64:67], s4 offen offset:2048 sc1
    buffer_load_dwordx4 v[160:163], v8, s[64:67], s4 offen offset:0 sc1
    buffer_load_dwordx4 v[164:167], v8, s[64:67], s4 offen offset:1024 sc1
    s_and_b32 s23, s85, 1
    s_lshl_b32 s3, s23, 6
    v_xor_b32 v1, s3, v60
    s_lshl_b32 s3, s30, 11
    s_add_u32 s3, s3, 153728
    v_xor_b32 v2, 0, v1
    v_add_u32 v2, s3, v2
    ds_read_b64_tr_b16 v[24:25], v2
    v_xor_b32 v2, 32, v1
    v_add_u32 v2, s3, v2
    ds_read_b64_tr_b16 v[26:27], v2
    v_xor_b32 v2, 64, v1
    v_add_u32 v2, s3, v2
    ds_read_b64_tr_b16 v[28:29], v2
    v_xor_b32 v2, 96, v1
    v_add_u32 v2, s3, v2
    ds_read_b64_tr_b16 v[30:31], v2
    s_waitcnt lgkmcnt(0)
    v_lshlrev_b32 v64, 16, v24
    v_and_b32 v65, 0xffff0000, v24
    v_lshlrev_b32 v66, 16, v25
    v_and_b32 v67, 0xffff0000, v25
    v_lshlrev_b32 v80, 16, v26
    v_and_b32 v81, 0xffff0000, v26
    v_lshlrev_b32 v82, 16, v27
    v_and_b32 v83, 0xffff0000, v27
    v_lshlrev_b32 v96, 16, v28
    v_and_b32 v97, 0xffff0000, v28
    v_lshlrev_b32 v98, 16, v29
    v_and_b32 v99, 0xffff0000, v29
    v_lshlrev_b32 v112, 16, v30
    v_and_b32 v113, 0xffff0000, v30
    v_lshlrev_b32 v114, 16, v31
    v_and_b32 v115, 0xffff0000, v31
    s_nop 1
    s_waitcnt vmcnt(9)
    v_mfma_f32_16x16x32_bf16 v[64:67], a[120:123], v[128:131], v[64:67]
    ds_read_b64_tr_b16 a[8:9], v48 offset:16640
    ds_read_b64_tr_b16 a[38:39], v49 offset:16640
    v_mfma_f32_16x16x32_bf16 v[68:71], a[150:153], v[128:131], 0
    ds_read_b64_tr_b16 a[68:69], v50 offset:16640
    ds_read_b64_tr_b16 a[98:99], v51 offset:16640
    v_mfma_f32_16x16x32_bf16 v[72:75], a[180:183], v[128:131], 0
    ds_read_b64_tr_b16 a[10:11], v48 offset:18688
    ds_read_b64_tr_b16 a[40:41], v49 offset:18688
    v_mfma_f32_16x16x32_bf16 v[76:79], a[210:213], v[128:131], 0
    buffer_load_dwordx4 v[168:171], v8, s[64:67], s4 offen offset:2048 sc1
    s_waitcnt vmcnt(9)
    v_mfma_f32_16x16x32_bf16 v[80:83], a[120:123], v[132:135], v[80:83]
    ds_read_b64_tr_b16 a[70:71], v50 offset:18688
    ds_read_b64_tr_b16 a[100:101], v51 offset:18688
    v_mfma_f32_16x16x32_bf16 v[84:87], a[150:153], v[132:135], 0
    ds_read_b64_tr_b16 a[12:13], v52 offset:33792
    ds_read_b64_tr_b16 a[42:43], v53 offset:33792
    v_mfma_f32_16x16x32_bf16 v[88:91], a[180:183], v[132:135], 0
    ds_read_b64_tr_b16 a[72:73], v54 offset:33792
    ds_read_b64_tr_b16 a[102:103], v55 offset:33792
    v_mfma_f32_16x16x32_bf16 v[92:95], a[210:213], v[132:135], 0
    buffer_load_dwordx4 v[172:175], v9, s[64:67], s4 offen offset:3072 sc1
    s_waitcnt vmcnt(9)
    v_mfma_f32_16x16x32_bf16 v[64:67], a[124:127], v[136:139], v[64:67]
    ds_read_b64_tr_b16 a[14:15], v48 offset:33280
    v_mfma_f32_16x16x32_bf16 v[68:71], a[154:157], v[136:139], v[68:71]
    ds_read_b64_tr_b16 a[44:45], v49 offset:33280
    v_mfma_f32_16x16x32_bf16 v[72:75], a[184:187], v[136:139], v[72:75]
    ds_read_b64_tr_b16 a[74:75], v50 offset:33280
    v_mfma_f32_16x16x32_bf16 v[76:79], a[214:217], v[136:139], v[76:79]
    buffer_load_dwordx4 v[176:179], v10, s[64:67], s4 offen offset:0 sc1
    s_waitcnt vmcnt(9)
    v_mfma_f32_16x16x32_bf16 v[80:83], a[124:127], v[140:143], v[80:83]
    ds_read_b64_tr_b16 a[104:105], v51 offset:33280
    v_mfma_f32_16x16x32_bf16 v[84:87], a[154:157], v[140:143], v[84:87]
    ds_read_b64_tr_b16 a[16:17], v48 offset:35328
    v_mfma_f32_16x16x32_bf16 v[88:91], a[184:187], v[140:143], v[88:91]
    ds_read_b64_tr_b16 a[28:29], v48 offset:35328
    v_mfma_f32_16x16x32_bf16 v[92:95], a[214:217], v[140:143], v[92:95]
    buffer_load_dwordx4 v[180:183], v10, s[64:67], s4 offen offset:1024 sc1
    s_waitcnt vmcnt(9)
    v_mfma_f32_16x16x32_bf16 v[64:67], a[128:131], v[144:147], v[64:67]
    ds_read_b64_tr_b16 a[46:47], v49 offset:35328
    v_mfma_f32_16x16x32_bf16 v[68:71], a[158:161], v[144:147], v[68:71]
    ds_read_b64_tr_b16 a[58:59], v49 offset:35328
    v_mfma_f32_16x16x32_bf16 v[72:75], a[188:191], v[144:147], v[72:75]
    ds_read_b64_tr_b16 a[76:77], v50 offset:35328
    v_mfma_f32_16x16x32_bf16 v[76:79], a[218:221], v[144:147], v[76:79]
    buffer_load_dwordx4 v[188:191], v22, s[64:67], s5 offen offset:0 sc1
    s_waitcnt vmcnt(9)
    v_mfma_f32_16x16x32_bf16 v[80:83], a[128:131], v[148:151], v[80:83]
    ds_read_b64_tr_b16 a[88:89], v50 offset:35328
    v_mfma_f32_16x16x32_bf16 v[84:87], a[158:161], v[148:151], v[84:87]
    ds_read_b64_tr_b16 a[106:107], v51 offset:35328
    v_mfma_f32_16x16x32_bf16 v[88:91], a[188:191], v[148:151], v[88:91]
    ds_read_b64_tr_b16 a[118:119], v51 offset:35328
    v_mfma_f32_16x16x32_bf16 v[92:95], a[218:221], v[148:151], v[92:95]
    buffer_load_dwordx4 v[192:195], v22, s[64:67], s5 offen offset:1024 sc1
    s_waitcnt vmcnt(9)
    v_mfma_f32_16x16x32_bf16 v[64:67], a[132:135], v[152:155], v[64:67]
    ds_read_b64_tr_b16 a[18:19], v52 offset:42240
    v_mfma_f32_16x16x32_bf16 v[68:71], a[162:165], v[152:155], v[68:71]
    ds_read_b64_tr_b16 a[48:49], v53 offset:42240
    v_mfma_f32_16x16x32_bf16 v[72:75], a[192:195], v[152:155], v[72:75]
    ds_read_b64_tr_b16 a[78:79], v54 offset:42240
    v_mfma_f32_16x16x32_bf16 v[76:79], a[222:225], v[152:155], v[76:79]
    buffer_load_dwordx4 v[196:199], v22, s[64:67], s5 offen offset:2048 sc1
    s_waitcnt vmcnt(9)
    v_mfma_f32_16x16x32_bf16 v[80:83], a[132:135], v[156:159], v[80:83]
    ds_read_b64_tr_b16 a[108:109], v55 offset:42240
    v_mfma_f32_16x16x32_bf16 v[84:87], a[162:165], v[156:159], v[84:87]
    ds_read_b64_tr_b16 a[20:21], v44 offset:0
    v_mfma_f32_16x16x32_bf16 v[88:91], a[192:195], v[156:159], v[88:91]
    ds_read_b64_tr_b16 a[50:51], v45 offset:0
    v_mfma_f32_16x16x32_bf16 v[92:95], a[222:225], v[156:159], v[92:95]
    buffer_load_dwordx4 v[200:203], v22, s[64:67], s5 offen offset:3072 sc1
    s_waitcnt vmcnt(8)
    v_mov_b32 v184, v160
    v_mov_b32 v185, v161
    v_mfma_f32_16x16x32_bf16 v[64:67], a[136:139], v[162:165], v[64:67]
    ds_read_b64_tr_b16 a[80:81], v46 offset:0
    v_mfma_f32_16x16x32_bf16 v[68:71], a[166:169], v[162:165], v[68:71]
    ds_read_b64_tr_b16 a[110:111], v47 offset:0
    v_mfma_f32_16x16x32_bf16 v[72:75], a[196:199], v[162:165], v[72:75]
    ds_read_b64_tr_b16 a[22:23], v44 offset:2048
    v_mfma_f32_16x16x32_bf16 v[76:79], a[226:229], v[162:165], v[76:79]
    buffer_load_dwordx4 v[204:207], v8, s[64:67], s5 offen offset:3072 sc1
    s_waitcnt vmcnt(8)
    v_mfma_f32_16x16x32_bf16 v[80:83], a[138:141], v[166:169], v[80:83]
    ds_read_b64_tr_b16 a[52:53], v45 offset:2048
    v_mfma_f32_16x16x32_bf16 v[84:87], a[168:171], v[166:169], v[84:87]
    ds_read_b64_tr_b16 a[82:83], v46 offset:2048
    v_mfma_f32_16x16x32_bf16 v[88:91], a[198:201], v[166:169], v[88:91]
    ds_read_b64_tr_b16 a[112:113], v47 offset:2048
    v_mfma_f32_16x16x32_bf16 v[92:95], a[228:231], v[166:169], v[92:95]
    buffer_load_dwordx4 v[208:211], v9, s[64:67], s5 offen offset:0 sc1
    s_waitcnt vmcnt(8)
    v_mfma_f32_16x16x32_bf16 v[64:67], a[140:143], v[170:173], v[64:67]
    ds_read_b64_tr_b16 a[24:25], v52 offset:0
    v_mfma_f32_16x16x32_bf16 v[68:71], a[170:173], v[170:173], v[68:71]
    ds_read_b64_tr_b16 a[54:55], v53 offset:0
    v_mfma_f32_16x16x32_bf16 v[72:75], a[200:203], v[170:173], v[72:75]
    ds_read_b64_tr_b16 a[84:85], v54 offset:0
    v_mfma_f32_16x16x32_bf16 v[76:79], a[230:233], v[170:173], v[76:79]
    buffer_load_dwordx4 v[212:215], v9, s[64:67], s5 offen offset:1024 sc1
    s_waitcnt vmcnt(8)
    v_mfma_f32_16x16x32_bf16 v[80:83], a[142:145], v[174:177], v[80:83]
    ds_read_b64_tr_b16 a[114:115], v55 offset:0
    v_mfma_f32_16x16x32_bf16 v[84:87], a[172:175], v[174:177], v[84:87]
    ds_read_b64_tr_b16 a[26:27], v44 offset:16640
    v_mfma_f32_16x16x32_bf16 v[88:91], a[202:205], v[174:177], v[88:91]
    ds_read_b64_tr_b16 a[56:57], v45 offset:16640
    v_mfma_f32_16x16x32_bf16 v[92:95], a[232:235], v[174:177], v[92:95]
    buffer_load_dwordx4 v[216:219], v9, s[64:67], s5 offen offset:2048 sc1
    s_waitcnt vmcnt(8)
    v_mfma_f32_16x16x32_bf16 v[64:67], a[144:147], v[178:181], v[64:67]
    ds_read_b64_tr_b16 a[86:87], v46 offset:16640
    v_mfma_f32_16x16x32_bf16 v[68:71], a[174:177], v[178:181], v[68:71]
    ds_read_b64_tr_b16 a[116:117], v47 offset:16640
    v_mfma_f32_16x16x32_bf16 v[72:75], a[204:207], v[178:181], v[72:75]
    v_mfma_f32_16x16x32_bf16 v[76:79], a[234:237], v[178:181], v[76:79]
    buffer_load_dwordx4 v[220:223], v8, s[64:67], s5 offen offset:0 sc1
    s_waitcnt vmcnt(9)
    v_mfma_f32_16x16x32_bf16 v[80:83], a[146:149], v[182:185], v[80:83]
    v_mfma_f32_16x16x32_bf16 v[84:87], a[176:179], v[182:185], v[84:87]
    v_mfma_f32_16x16x32_bf16 v[88:91], a[206:209], v[182:185], v[88:91]
    v_mfma_f32_16x16x32_bf16 v[92:95], a[236:239], v[182:185], v[92:95]
    buffer_load_dwordx4 v[224:227], v8, s[64:67], s5 offen offset:1024 sc1
    s_waitcnt lgkmcnt(0)
    s_waitcnt vmcnt(9)
    v_mfma_f32_16x16x32_bf16 v[64:67], a[0:3], v[188:191], v[64:67]
    v_lshrrev_b32 v1, 4, v0
    v_mfma_f32_16x16x32_bf16 v[68:71], a[30:33], v[188:191], v[68:71]
    v_mul_u32_u24 v1, 272, v1
    v_mfma_f32_16x16x32_bf16 v[72:75], a[60:63], v[188:191], v[72:75]
    v_and_b32 v2, 15, v0
    v_mfma_f32_16x16x32_bf16 v[76:79], a[90:93], v[188:191], v[76:79]
    buffer_load_dwordx4 v[228:231], v8, s[64:67], s5 offen offset:2048 sc1
    s_waitcnt vmcnt(9)
    v_mfma_f32_16x16x32_bf16 v[80:83], a[0:3], v[192:195], v[80:83]
    v_lshl_add_u32 v1, v2, 4, v1
    v_mfma_f32_16x16x32_bf16 v[84:87], a[30:33], v[192:195], v[84:87]
    s_xor_b32 s3, s30, 0
    v_mfma_f32_16x16x32_bf16 v[88:91], a[60:63], v[192:195], v[88:91]
    s_mul_i32 s3, s3, 1088
    v_mfma_f32_16x16x32_bf16 v[92:95], a[90:93], v[192:195], v[92:95]
    buffer_load_dwordx4 v[232:235], v9, s[64:67], s5 offen offset:3072 sc1
    s_waitcnt vmcnt(9)
    v_mfma_f32_16x16x32_bf16 v[64:67], a[4:7], v[196:199], v[64:67]
    s_mul_i32 s74, s30, 8704
    v_mfma_f32_16x16x32_bf16 v[68:71], a[34:37], v[196:199], v[68:71]
    s_add_u32 s3, s3, s74
    v_mfma_f32_16x16x32_bf16 v[72:75], a[64:67], v[196:199], v[72:75]
    v_add_u32 v12, s3, v1
    v_mfma_f32_16x16x32_bf16 v[76:79], a[94:97], v[196:199], v[76:79]
    buffer_load_dwordx4 v[236:239], v10, s[64:67], s5 offen offset:0 sc1
    s_waitcnt vmcnt(9)
    v_mfma_f32_16x16x32_bf16 v[80:83], a[4:7], v[200:203], v[80:83]
    s_xor_b32 s3, s30, 1
    v_mfma_f32_16x16x32_bf16 v[84:87], a[34:37], v[200:203], v[84:87]
    s_mul_i32 s3, s3, 1088
    v_mfma_f32_16x16x32_bf16 v[88:91], a[64:67], v[200:203], v[88:91]
    s_mul_i32 s74, s30, 8704
    v_mfma_f32_16x16x32_bf16 v[92:95], a[94:97], v[200:203], v[92:95]
    buffer_load_dwordx4 v[240:243], v10, s[64:67], s5 offen offset:1024 sc1
    s_waitcnt vmcnt(9)
    v_mfma_f32_16x16x32_bf16 v[64:67], a[8:11], v[204:207], v[64:67]
    s_add_u32 s3, s3, s74
    v_mfma_f32_16x16x32_bf16 v[68:71], a[38:41], v[204:207], v[68:71]
    v_add_u32 v13, s3, v1
    v_mfma_f32_16x16x32_bf16 v[72:75], a[68:71], v[204:207], v[72:75]
    s_xor_b32 s3, s30, 2
    v_mfma_f32_16x16x32_bf16 v[76:79], a[98:101], v[204:207], v[76:79]
    buffer_load_dwordx4 v[128:131], v22, s[64:67], s6 offen offset:0 sc1
    s_waitcnt vmcnt(9)
    v_mfma_f32_16x16x32_bf16 v[80:83], a[8:11], v[208:211], v[80:83]
    s_mul_i32 s3, s3, 1088
    v_mfma_f32_16x16x32_bf16 v[84:87], a[38:41], v[208:211], v[84:87]
    s_mul_i32 s74, s30, 8704
    v_mfma_f32_16x16x32_bf16 v[88:91], a[68:71], v[208:211], v[88:91]
    s_add_u32 s3, s3, s74
    v_mfma_f32_16x16x32_bf16 v[92:95], a[98:101], v[208:211], v[92:95]
    buffer_load_dwordx4 v[132:135], v22, s[64:67], s6 offen offset:1024 sc1
    s_waitcnt vmcnt(9)
    v_mfma_f32_16x16x32_bf16 v[64:67], a[12:15], v[212:215], v[64:67]
    v_add_u32 v14, s3, v1
    v_mfma_f32_16x16x32_bf16 v[68:71], a[42:45], v[212:215], v[68:71]
    s_xor_b32 s3, s30, 3
    v_mfma_f32_16x16x32_bf16 v[72:75], a[72:75], v[212:215], v[72:75]
    s_mul_i32 s3, s3, 1088
    v_mfma_f32_16x16x32_bf16 v[76:79], a[102:105], v[212:215], v[76:79]
    buffer_load_dwordx4 v[136:139], v22, s[64:67], s6 offen offset:2048 sc1
    s_waitcnt vmcnt(9)
    v_mfma_f32_16x16x32_bf16 v[80:83], a[12:15], v[216:219], v[80:83]
    s_mul_i32 s74, s30, 8704
    v_mfma_f32_16x16x32_bf16 v[84:87], a[42:45], v[216:219], v[84:87]
    s_add_u32 s3, s3, s74
    v_mfma_f32_16x16x32_bf16 v[88:91], a[72:75], v[216:219], v[88:91]
    v_add_u32 v15, s3, v1
    v_mfma_f32_16x16x32_bf16 v[92:95], a[102:105], v[216:219], v[92:95]
    buffer_load_dwordx4 v[140:143], v22, s[64:67], s6 offen offset:3072 sc1
    s_waitcnt vmcnt(8)
    v_mov_b32 v244, v220
    v_mov_b32 v245, v221
    v_mfma_f32_16x16x32_bf16 v[64:67], a[16:19], v[222:225], v[64:67]
    v_and_b32 v1, 7, v0
    v_mfma_f32_16x16x32_bf16 v[68:71], a[46:49], v[222:225], v[68:71]
    v_lshrrev_b32 v2, 3, v0
    v_mfma_f32_16x16x32_bf16 v[72:75], a[76:79], v[222:225], v[72:75]
    v_mul_u32_u24 v16, 544, v1
    v_mfma_f32_16x16x32_bf16 v[76:79], a[106:109], v[222:225], v[76:79]
    buffer_load_dwordx4 v[144:147], v8, s[64:67], s6 offen offset:3072 sc1
    s_waitcnt vmcnt(8)
    v_mfma_f32_16x16x32_bf16 v[80:83], a[18:21], v[226:229], v[80:83]
    v_lshl_add_u32 v16, v2, 4, v16
    v_mfma_f32_16x16x32_bf16 v[84:87], a[48:51], v[226:229], v[84:87]
    s_mul_i32 s3, s82, 4352
    v_mfma_f32_16x16x32_bf16 v[88:91], a[78:81], v[226:229], v[88:91]
    s_lshl_b32 s74, s94, 7
    v_mfma_f32_16x16x32_bf16 v[92:95], a[108:111], v[226:229], v[92:95]
    buffer_load_dwordx4 v[148:151], v9, s[64:67], s6 offen offset:0 sc1
    s_waitcnt vmcnt(8)
    v_mfma_f32_16x16x32_bf16 v[64:67], a[20:23], v[230:233], v[64:67]
    s_add_u32 s3, s3, s74
    v_mfma_f32_16x16x32_bf16 v[68:71], a[50:53], v[230:233], v[68:71]
    v_add_u32 v16, s3, v16
    v_mfma_f32_16x16x32_bf16 v[72:75], a[80:83], v[230:233], v[72:75]
    v_lshlrev_b32 v17, 10, v2
    v_mfma_f32_16x16x32_bf16 v[76:79], a[110:113], v[230:233], v[76:79]
    buffer_load_dwordx4 v[152:155], v9, s[64:67], s6 offen offset:1024 sc1
    s_waitcnt vmcnt(8)
    v_mfma_f32_16x16x32_bf16 v[80:83], a[22:25], v[234:237], v[80:83]
    v_lshl_add_u32 v17, v1, 4, v17
    v_mfma_f32_16x16x32_bf16 v[84:87], a[52:55], v[234:237], v[84:87]
    s_lshl_b32 s3, s84, 1
    v_mfma_f32_16x16x32_bf16 v[88:91], a[82:85], v[234:237], v[88:91]
    s_add_u32 s3, s3, s23
    v_mfma_f32_16x16x32_bf16 v[92:95], a[112:115], v[234:237], v[92:95]
    buffer_load_dwordx4 v[156:159], v9, s[64:67], s6 offen offset:2048 sc1
    s_waitcnt vmcnt(8)
    v_mfma_f32_16x16x32_bf16 v[64:67], a[24:27], v[238:241], v[64:67]
    s_lshl_b32 s3, s3, 2
    v_mfma_f32_16x16x32_bf16 v[68:71], a[54:57], v[238:241], v[68:71]
    s_add_u32 s3, s3, s30
    v_mfma_f32_16x16x32_bf16 v[72:75], a[84:87], v[238:241], v[72:75]
    s_lshl_b32 s3, s3, 13
    v_mfma_f32_16x16x32_bf16 v[76:79], a[114:117], v[238:241], v[76:79]
    buffer_load_dwordx4 v[160:163], v8, s[64:67], s6 offen offset:0 sc1
    s_waitcnt vmcnt(9)
    v_mfma_f32_16x16x32_bf16 v[80:83], a[26:29], v[242:245], v[80:83]
    s_lshl_b32 s74, s85, 7
    v_mfma_f32_16x16x32_bf16 v[84:87], a[56:59], v[242:245], v[84:87]
    s_add_u32 s8, s3, s74
    v_mfma_f32_16x16x32_bf16 v[88:91], a[86:89], v[242:245], v[88:91]
    s_xor_b32 s9, s8, 32768
    v_mfma_f32_16x16x32_bf16 v[92:95], a[116:119], v[242:245], v[92:95]
    buffer_load_dwordx4 v[164:167], v8, s[64:67], s6 offen offset:1024 sc1
    s_waitcnt vmcnt(9)
    v_mfma_f32_16x16x32_bf16 v[96:99], a[120:123], v[128:131], v[96:99]
    v_mfma_f32_16x16x32_bf16 v[100:103], a[150:153], v[128:131], 0
    v_mfma_f32_16x16x32_bf16 v[104:107], a[180:183], v[128:131], 0
    v_mfma_f32_16x16x32_bf16 v[108:111], a[210:213], v[128:131], 0
    buffer_load_dwordx4 v[168:171], v8, s[64:67], s6 offen offset:2048 sc1
    s_waitcnt vmcnt(9)
    v_mfma_f32_16x16x32_bf16 v[112:115], a[120:123], v[132:135], v[112:115]
    s_barrier
    v_mfma_f32_16x16x32_bf16 v[116:119], a[150:153], v[132:135], 0
    ds_write_b128 v12, v[64:67] offset:0
    v_mfma_f32_16x16x32_bf16 v[120:123], a[180:183], v[132:135], 0
    ds_write_b128 v13, v[68:71] offset:0
    v_mfma_f32_16x16x32_bf16 v[124:127], a[210:213], v[132:135], 0
    buffer_load_dwordx4 v[172:175], v9, s[64:67], s6 offen offset:3072 sc1
    s_waitcnt vmcnt(9)
    v_mfma_f32_16x16x32_bf16 v[96:99], a[124:127], v[136:139], v[96:99]
    ds_write_b128 v14, v[72:75] offset:0
    v_mfma_f32_16x16x32_bf16 v[100:103], a[154:157], v[136:139], v[100:103]
    ds_write_b128 v15, v[76:79] offset:0
    v_mfma_f32_16x16x32_bf16 v[104:107], a[184:187], v[136:139], v[104:107]
    ds_write_b128 v12, v[80:83] offset:4352
    v_mfma_f32_16x16x32_bf16 v[108:111], a[214:217], v[136:139], v[108:111]
    buffer_load_dwordx4 v[176:179], v10, s[64:67], s6 offen offset:0 sc1
    s_waitcnt vmcnt(9)
    v_mfma_f32_16x16x32_bf16 v[112:115], a[124:127], v[140:143], v[112:115]
    ds_write_b128 v13, v[84:87] offset:4352
    v_mfma_f32_16x16x32_bf16 v[116:119], a[154:157], v[140:143], v[116:119]
    ds_write_b128 v14, v[88:91] offset:4352
    v_mfma_f32_16x16x32_bf16 v[120:123], a[184:187], v[140:143], v[120:123]
    ds_write_b128 v15, v[92:95] offset:4352
    v_mfma_f32_16x16x32_bf16 v[124:127], a[214:217], v[140:143], v[124:127]
    buffer_load_dwordx4 v[180:183], v10, s[64:67], s6 offen offset:1024 sc1
    s_waitcnt vmcnt(9)
    v_mfma_f32_16x16x32_bf16 v[96:99], a[128:131], v[144:147], v[96:99]
    v_mfma_f32_16x16x32_bf16 v[100:103], a[158:161], v[144:147], v[100:103]
    v_mfma_f32_16x16x32_bf16 v[104:107], a[188:191], v[144:147], v[104:107]
    v_mfma_f32_16x16x32_bf16 v[108:111], a[218:221], v[144:147], v[108:111]
    buffer_load_dwordx4 v[188:191], v22, s[64:67], s7 offen offset:0 sc1
    s_waitcnt vmcnt(9)
    v_mfma_f32_16x16x32_bf16 v[112:115], a[128:131], v[148:151], v[112:115]
    v_mfma_f32_16x16x32_bf16 v[116:119], a[158:161], v[148:151], v[116:119]
    s_waitcnt lgkmcnt(0)
    v_mfma_f32_16x16x32_bf16 v[120:123], a[188:191], v[148:151], v[120:123]
    s_barrier
    v_mfma_f32_16x16x32_bf16 v[124:127], a[218:221], v[148:151], v[124:127]
    buffer_load_dwordx4 v[192:195], v22, s[64:67], s7 offen offset:1024 sc1
    s_waitcnt vmcnt(9)
    v_mfma_f32_16x16x32_bf16 v[96:99], a[132:135], v[152:155], v[96:99]
    ds_read_b128 v[24:27], v16 offset:0
    v_mfma_f32_16x16x32_bf16 v[100:103], a[162:165], v[152:155], v[100:103]
    ds_read_b128 v[28:31], v16 offset:272
    v_mfma_f32_16x16x32_bf16 v[104:107], a[192:195], v[152:155], v[104:107]
    ds_read_b128 v[32:35], v16 offset:8704
    v_mfma_f32_16x16x32_bf16 v[108:111], a[222:225], v[152:155], v[108:111]
    buffer_load_dwordx4 v[196:199], v22, s[64:67], s7 offen offset:2048 sc1
    s_waitcnt vmcnt(9)
    v_mfma_f32_16x16x32_bf16 v[112:115], a[132:135], v[156:159], v[112:115]
    ds_read_b128 v[36:39], v16 offset:8976
    v_mfma_f32_16x16x32_bf16 v[116:119], a[162:165], v[156:159], v[116:119]
    ds_read_b128 v[40:43], v16 offset:17408
    v_mfma_f32_16x16x32_bf16 v[120:123], a[192:195], v[156:159], v[120:123]
    ds_read_b128 v[44:47], v16 offset:17680
    v_mfma_f32_16x16x32_bf16 v[124:127], a[222:225], v[156:159], v[124:127]
    buffer_load_dwordx4 v[200:203], v22, s[64:67], s7 offen offset:3072 sc1
    s_waitcnt vmcnt(8)
    v_mov_b32 v184, v160
    v_mov_b32 v185, v161
    v_mfma_f32_16x16x32_bf16 v[96:99], a[136:139], v[162:165], v[96:99]
    ds_read_b128 v[48:51], v16 offset:26112
    v_mfma_f32_16x16x32_bf16 v[100:103], a[166:169], v[162:165], v[100:103]
    ds_read_b128 v[52:55], v16 offset:26384
    v_mfma_f32_16x16x32_bf16 v[104:107], a[196:199], v[162:165], v[104:107]
    v_mfma_f32_16x16x32_bf16 v[108:111], a[226:229], v[162:165], v[108:111]
    buffer_load_dwordx4 v[204:207], v8, s[64:67], s7 offen offset:3072 sc1
    s_waitcnt vmcnt(8)
    v_mfma_f32_16x16x32_bf16 v[112:115], a[138:141], v[166:169], v[112:115]
    v_mfma_f32_16x16x32_bf16 v[116:119], a[168:171], v[166:169], v[116:119]
    v_mfma_f32_16x16x32_bf16 v[120:123], a[198:201], v[166:169], v[120:123]
    v_mfma_f32_16x16x32_bf16 v[124:127], a[228:231], v[166:169], v[124:127]
    buffer_load_dwordx4 v[208:211], v9, s[64:67], s7 offen offset:0 sc1
    s_waitcnt vmcnt(8)
    v_mfma_f32_16x16x32_bf16 v[96:99], a[140:143], v[170:173], v[96:99]
    v_mfma_f32_16x16x32_bf16 v[100:103], a[170:173], v[170:173], v[100:103]
    v_mfma_f32_16x16x32_bf16 v[104:107], a[200:203], v[170:173], v[104:107]
    s_waitcnt lgkmcnt(0)
    v_mfma_f32_16x16x32_bf16 v[108:111], a[230:233], v[170:173], v[108:111]
    buffer_load_dwordx4 v[212:215], v9, s[64:67], s7 offen offset:1024 sc1
    s_waitcnt vmcnt(8)
    v_mfma_f32_16x16x32_bf16 v[112:115], a[142:145], v[174:177], v[112:115]
    v_add_f32 v24, v24, v32
    v_mfma_f32_16x16x32_bf16 v[116:119], a[172:175], v[174:177], v[116:119]
    v_add_f32 v25, v25, v33
    v_mfma_f32_16x16x32_bf16 v[120:123], a[202:205], v[174:177], v[120:123]
    v_add_f32 v26, v26, v34
    v_mfma_f32_16x16x32_bf16 v[124:127], a[232:235], v[174:177], v[124:127]
    buffer_load_dwordx4 v[216:219], v9, s[64:67], s7 offen offset:2048 sc1
    s_waitcnt vmcnt(8)
    v_mfma_f32_16x16x32_bf16 v[96:99], a[144:147], v[178:181], v[96:99]
    v_add_f32 v27, v27, v35
    v_mfma_f32_16x16x32_bf16 v[100:103], a[174:177], v[178:181], v[100:103]
    v_add_f32 v28, v28, v36
    v_mfma_f32_16x16x32_bf16 v[104:107], a[204:207], v[178:181], v[104:107]
    v_add_f32 v29, v29, v37
    v_mfma_f32_16x16x32_bf16 v[108:111], a[234:237], v[178:181], v[108:111]
    buffer_load_dwordx4 v[220:223], v8, s[64:67], s7 offen offset:0 sc1
    s_waitcnt vmcnt(9)
    v_mfma_f32_16x16x32_bf16 v[112:115], a[146:149], v[182:185], v[112:115]
    v_add_f32 v30, v30, v38
    v_mfma_f32_16x16x32_bf16 v[116:119], a[176:179], v[182:185], v[116:119]
    v_add_f32 v31, v31, v39
    v_mfma_f32_16x16x32_bf16 v[120:123], a[206:209], v[182:185], v[120:123]
    v_add_f32 v40, v40, v48
    v_mfma_f32_16x16x32_bf16 v[124:127], a[236:239], v[182:185], v[124:127]
    buffer_load_dwordx4 v[224:227], v8, s[64:67], s7 offen offset:1024 sc1
    s_waitcnt vmcnt(9)
    v_mfma_f32_16x16x32_bf16 v[96:99], a[0:3], v[188:191], v[96:99]
    v_add_f32 v41, v41, v49
    v_mfma_f32_16x16x32_bf16 v[100:103], a[30:33], v[188:191], v[100:103]
    v_add_f32 v42, v42, v50
    v_mfma_f32_16x16x32_bf16 v[104:107], a[60:63], v[188:191], v[104:107]
    v_add_f32 v43, v43, v51
    v_mfma_f32_16x16x32_bf16 v[108:111], a[90:93], v[188:191], v[108:111]
    buffer_load_dwordx4 v[228:231], v8, s[64:67], s7 offen offset:2048 sc1
    s_waitcnt vmcnt(9)
    v_mfma_f32_16x16x32_bf16 v[112:115], a[0:3], v[192:195], v[112:115]
    v_add_f32 v44, v44, v52
    v_mfma_f32_16x16x32_bf16 v[116:119], a[30:33], v[192:195], v[116:119]
    v_add_f32 v45, v45, v53
    v_mfma_f32_16x16x32_bf16 v[120:123], a[60:63], v[192:195], v[120:123]
    v_add_f32 v46, v46, v54
    v_mfma_f32_16x16x32_bf16 v[124:127], a[90:93], v[192:195], v[124:127]
    buffer_load_dwordx4 v[232:235], v9, s[64:67], s7 offen offset:3072 sc1
    s_waitcnt vmcnt(9)
    v_mfma_f32_16x16x32_bf16 v[96:99], a[4:7], v[196:199], v[96:99]
    v_add_f32 v47, v47, v55
    v_mfma_f32_16x16x32_bf16 v[100:103], a[34:37], v[196:199], v[100:103]
    v_add_f32 v24, v24, v40
    v_mfma_f32_16x16x32_bf16 v[104:107], a[64:67], v[196:199], v[104:107]
    v_add_f32 v25, v25, v41
    v_mfma_f32_16x16x32_bf16 v[108:111], a[94:97], v[196:199], v[108:111]
    buffer_load_dwordx4 v[236:239], v10, s[64:67], s7 offen offset:0 sc1
    s_waitcnt vmcnt(9)
    v_mfma_f32_16x16x32_bf16 v[112:115], a[4:7], v[200:203], v[112:115]
    v_add_f32 v26, v26, v42
    v_mfma_f32_16x16x32_bf16 v[116:119], a[34:37], v[200:203], v[116:119]
    v_add_f32 v27, v27, v43
    v_mfma_f32_16x16x32_bf16 v[120:123], a[64:67], v[200:203], v[120:123]
    v_add_f32 v28, v28, v44
    v_mfma_f32_16x16x32_bf16 v[124:127], a[94:97], v[200:203], v[124:127]
    buffer_load_dwordx4 v[240:243], v10, s[64:67], s7 offen offset:1024 sc1
    s_waitcnt vmcnt(9)
    v_mfma_f32_16x16x32_bf16 v[96:99], a[8:11], v[204:207], v[96:99]
    v_add_f32 v29, v29, v45
    v_mfma_f32_16x16x32_bf16 v[100:103], a[38:41], v[204:207], v[100:103]
    v_add_f32 v30, v30, v46
    v_mfma_f32_16x16x32_bf16 v[104:107], a[68:71], v[204:207], v[104:107]
    v_add_f32 v31, v31, v47
    v_mfma_f32_16x16x32_bf16 v[108:111], a[98:101], v[204:207], v[108:111]
    v_cvt_pk_bf16_f32 v56, v24, v25
    s_waitcnt vmcnt(8)
    v_mfma_f32_16x16x32_bf16 v[112:115], a[8:11], v[208:211], v[112:115]
    v_cvt_pk_bf16_f32 v57, v26, v27
    v_mfma_f32_16x16x32_bf16 v[116:119], a[38:41], v[208:211], v[116:119]
    v_cvt_pk_bf16_f32 v58, v28, v29
    v_mfma_f32_16x16x32_bf16 v[120:123], a[68:71], v[208:211], v[120:123]
    v_cvt_pk_bf16_f32 v59, v30, v31
    v_mfma_f32_16x16x32_bf16 v[124:127], a[98:101], v[208:211], v[124:127]
    buffer_store_dwordx4 v[56:59], v17, s[60:63], s8 offen
    s_waitcnt vmcnt(8)
    v_mfma_f32_16x16x32_bf16 v[96:99], a[12:15], v[212:215], v[96:99]
    v_mfma_f32_16x16x32_bf16 v[100:103], a[42:45], v[212:215], v[100:103]
    v_mfma_f32_16x16x32_bf16 v[104:107], a[72:75], v[212:215], v[104:107]
    v_mfma_f32_16x16x32_bf16 v[108:111], a[102:105], v[212:215], v[108:111]
    s_waitcnt vmcnt(7)
    v_mfma_f32_16x16x32_bf16 v[112:115], a[12:15], v[216:219], v[112:115]
    v_mfma_f32_16x16x32_bf16 v[116:119], a[42:45], v[216:219], v[116:119]
    v_mfma_f32_16x16x32_bf16 v[120:123], a[72:75], v[216:219], v[120:123]
    v_mfma_f32_16x16x32_bf16 v[124:127], a[102:105], v[216:219], v[124:127]
    s_waitcnt vmcnt(5)
    v_mov_b32 v244, v220
    v_mov_b32 v245, v221
    v_mfma_f32_16x16x32_bf16 v[96:99], a[16:19], v[222:225], v[96:99]
    v_mfma_f32_16x16x32_bf16 v[100:103], a[46:49], v[222:225], v[100:103]
    v_mfma_f32_16x16x32_bf16 v[104:107], a[76:79], v[222:225], v[104:107]
    v_mfma_f32_16x16x32_bf16 v[108:111], a[106:109], v[222:225], v[108:111]
    s_waitcnt vmcnt(3)
    v_mfma_f32_16x16x32_bf16 v[96:99], a[20:23], v[230:233], v[96:99]
    v_mfma_f32_16x16x32_bf16 v[100:103], a[50:53], v[230:233], v[100:103]
    v_mfma_f32_16x16x32_bf16 v[104:107], a[80:83], v[230:233], v[104:107]
    v_mfma_f32_16x16x32_bf16 v[108:111], a[110:113], v[230:233], v[108:111]
    s_waitcnt vmcnt(1)
    v_mfma_f32_16x16x32_bf16 v[96:99], a[24:27], v[238:241], v[96:99]
    v_mfma_f32_16x16x32_bf16 v[100:103], a[54:57], v[238:241], v[100:103]
    v_mfma_f32_16x16x32_bf16 v[104:107], a[84:87], v[238:241], v[104:107]
    v_mfma_f32_16x16x32_bf16 v[108:111], a[114:117], v[238:241], v[108:111]
    s_waitcnt vmcnt(4)
    v_mfma_f32_16x16x32_bf16 v[112:115], a[18:21], v[226:229], v[112:115]
    v_mfma_f32_16x16x32_bf16 v[116:119], a[48:51], v[226:229], v[116:119]
    v_mfma_f32_16x16x32_bf16 v[120:123], a[78:81], v[226:229], v[120:123]
    ds_write_b128 v12, v[96:99] offset:34816
    v_mfma_f32_16x16x32_bf16 v[124:127], a[108:111], v[226:229], v[124:127]
    ds_write_b128 v13, v[100:103] offset:34816
    s_waitcnt vmcnt(2)
    v_mfma_f32_16x16x32_bf16 v[112:115], a[22:25], v[234:237], v[112:115]
    ds_write_b128 v14, v[104:107] offset:34816
    v_mfma_f32_16x16x32_bf16 v[116:119], a[52:55], v[234:237], v[116:119]
    ds_write_b128 v15, v[108:111] offset:34816
    v_mfma_f32_16x16x32_bf16 v[120:123], a[82:85], v[234:237], v[120:123]
    v_mfma_f32_16x16x32_bf16 v[124:127], a[112:115], v[234:237], v[124:127]
    s_waitcnt vmcnt(1)
    v_mfma_f32_16x16x32_bf16 v[112:115], a[26:29], v[242:245], v[112:115]
    v_mfma_f32_16x16x32_bf16 v[116:119], a[56:59], v[242:245], v[116:119]
    v_mfma_f32_16x16x32_bf16 v[120:123], a[86:89], v[242:245], v[120:123]
    v_mfma_f32_16x16x32_bf16 v[124:127], a[116:119], v[242:245], v[124:127]
    s_nop 7
    ds_write_b128 v12, v[112:115] offset:39168
    ds_write_b128 v13, v[116:119] offset:39168
    ds_write_b128 v14, v[120:123] offset:39168
    ds_write_b128 v15, v[124:127] offset:39168
    s_waitcnt lgkmcnt(0)
    s_barrier
    ds_read_b128 v[24:27], v16 offset:34816
    ds_read_b128 v[28:31], v16 offset:35088
    ds_read_b128 v[32:35], v16 offset:43520
    ds_read_b128 v[36:39], v16 offset:43792
    ds_read_b128 v[40:43], v16 offset:52224
    ds_read_b128 v[44:47], v16 offset:52496
    ds_read_b128 v[48:51], v16 offset:60928
    ds_read_b128 v[52:55], v16 offset:61200
    s_waitcnt lgkmcnt(4)
    v_pk_add_f32 v[24:25], v[24:25], v[32:33]
    v_pk_add_f32 v[26:27], v[26:27], v[34:35]
    v_pk_add_f32 v[28:29], v[28:29], v[36:37]
    v_pk_add_f32 v[30:31], v[30:31], v[38:39]
    s_waitcnt lgkmcnt(0)
    v_pk_add_f32 v[40:41], v[40:41], v[48:49]
    v_pk_add_f32 v[42:43], v[42:43], v[50:51]
    v_pk_add_f32 v[44:45], v[44:45], v[52:53]
    v_pk_add_f32 v[46:47], v[46:47], v[54:55]
    v_pk_add_f32 v[24:25], v[24:25], v[40:41]
    v_pk_add_f32 v[26:27], v[26:27], v[42:43]
    v_pk_add_f32 v[28:29], v[28:29], v[44:45]
    v_pk_add_f32 v[30:31], v[30:31], v[46:47]
    v_cvt_pk_bf16_f32 v56, v24, v25
    v_cvt_pk_bf16_f32 v57, v26, v27
    v_cvt_pk_bf16_f32 v58, v28, v29
    v_cvt_pk_bf16_f32 v59, v30, v31
    buffer_store_dwordx4 v[56:59], v17, s[60:63], s9 offen
L_finish:
L_end:
    s_endpgm
.section .rodata,"a"
.p2align 6
.amdhsa_kernel sequential_preLN__ssm_conv_h3__geglu_ffn__prompt_kernel
  .amdhsa_next_free_vgpr 512
  .amdhsa_next_free_sgpr 102
  .amdhsa_accum_offset 256
  .amdhsa_group_segment_fixed_size 0
  .amdhsa_kernarg_size 104
  .amdhsa_user_sgpr_count 2
  .amdhsa_user_sgpr_kernarg_segment_ptr 1
  .amdhsa_system_sgpr_workgroup_id_x 1
.end_amdhsa_kernel
```
